```python
import torch

def _softmax(x, axis=-1):
    return torch.softmax(x, dim=axis)
def _gelu(x):
    return torch.nn.functional.gelu(x, approximate="tanh")
def _silu(x):
    return torch.nn.functional.silu(x)
def _sigmoid(x):
    return torch.sigmoid(x)
def _layernorm(x, axis=-1, eps=1e-5):
    m = x.mean(dim=axis, keepdim=True)
    v = x.var(dim=axis, keepdim=True, unbiased=False)
    return (x - m) / torch.sqrt(v + eps)
def _scatter_add(tgt, idx, src, axis=0):
    return tgt.clone().index_add_(axis, idx, src)
def _segment_sum(src, seg, n):
    out = torch.zeros((n,) + src.shape[1:], dtype=src.dtype)
    return out.index_add_(0, seg, src)
def _pad(x, pw):
    flat = tuple(v for pair in reversed(pw) for v in pair)
    return torch.nn.functional.pad(x, flat)

kernel_name = 'standalone__deep_cross_pnn__recsys'

def setup_inputs():

    _w = (lambda a: (lambda t: t.to(torch.bfloat16) if t.is_floating_point() else t)(torch.as_tensor(a)))
    B, F, D, V = 16384, 26, 64, min(1000, 100000)
    H = 4 * D
    return {
        "idx": _w((lambda lo, hi, *s: torch.randint(lo, hi, s))(0, V, B, F).to(torch.int64)),
        "table": _w((lambda *s: torch.randn(*s, dtype=torch.bfloat16) * 3.2)(V, D) * (D ** -0.5)),
        "w_p": _w((lambda *s: torch.randn(*s, dtype=torch.bfloat16) * 0.05)(F * F) * ((F * F) ** -0.5)),
        "w1": _w((lambda *s: torch.randn(*s, dtype=torch.bfloat16) * 3.2)(F * D, H) * ((F * D) ** -0.5)),
        "b1": _w((lambda *s: torch.randn(*s, dtype=torch.bfloat16) * 3.2)(H) * 0.01),
        "w2": _w((lambda *s: torch.randn(*s, dtype=torch.bfloat16) * 0.05)(H) * (H ** -0.5)),
        "b2": _w((lambda *s: torch.randn(*s, dtype=torch.bfloat16) * 0.05)(1) * 0.01),
    }

def reference(idx, table, w_p, w1, b1, w2, b2):
    emb = table[idx]
    B = emb.shape[0]; F = emb.shape[1]; D = emb.shape[2]
    ip = torch.einsum('bid,bjd->bij', emb, emb)
    ip = ip.reshape(B, F * F)
    logit_p = ip @ w_p
    z = emb.reshape(B, F * D)
    h = _gelu(z @ w1 + b1)
    logit_d = h @ w2 + b2
    return logit_p + logit_d
```

```asm
; @launch grid=(256,1,1) block=(256,1,1) lds=149504
.amdgcn_target "amdgcn-amd-amdhsa--gfx950"
.text
.globl standalone__deep_cross_pnn__recsys_kernel
.p2align 8
.type standalone__deep_cross_pnn__recsys_kernel,@function
standalone__deep_cross_pnn__recsys_kernel:
    s_cmpk_ge_u32 s2, 0x100
    s_cbranch_scc1 L_end
    s_load_dwordx16 s[4:19], s[0:1], 0
    v_lshrrev_b32 v165, 6, v0
    v_and_b32 v160, 63, v0
    v_readfirstlane_b32 s76, v165
    s_getpc_b64 s[88:89]
L_pc:
    s_mov_b32 s90, L_end - L_pc
    s_mov_b32 s91, 0x20000
    v_lshlrev_b32 v36, 14, v160
    s_lshr_b32 s79, s2, 3
    s_lshl_b32 s81, s79, 2
    s_add_u32 s96, s81, s76
    s_lshl_b32 s81, s96, 7
    buffer_load_dword v28, v36, s[88:91], s81 offen
    v_lshlrev_b32 v164, 4, v160
    v_lshrrev_b32 v165, 2, v160
    v_and_b32 v166, 3, v160
    v_lshlrev_b32 v163, 7, v165
    v_lshl_add_u32 v163, v166, 4, v163
    v_add_u32 v171, 64, v163
    s_mov_b32 s22, 128000
    s_mov_b32 s23, s91
    s_mov_b32 s30, 1703936
    s_mov_b32 s31, s91
    v_lshlrev_b32 v62, 13, v160
    s_and_b32 s42, s79, 1
    s_andn2_b32 s43, s79, 1
    s_lshr_b32 s79, s79, 1
    s_lshl_b32 s43, s43, 2
    s_and_b32 s2, s2, 7
    s_add_u32 s43, s43, s2
    s_lshl1_add_u32 s2, s43, s42
    s_mulk_i32 s43, 0x3400
    s_mul_i32 s3, s76, 3328
    s_add_u32 s43, s43, s3
    s_addk_i32 s3, 0x1400
    s_mov_b32 s69, 64512
    s_sub_u32 s70, 4096, s69
    s_movk_i32 s71, 0x2000
    s_lshl_b32 s72, s76, 11
    s_lshl_b32 s47, s76, 10
    s_add_u32 m0, s47, 19456
    s_lshr_b32 s77, s76, 1
    s_mul_i32 s90, s77, 425984
    s_lshl_b32 s78, s42, 8
    s_add_u32 s48, s90, s78
    s_lshl_b32 s97, s79, 9
    s_add_u32 s97, s97, s48
    s_and_b32 s96, s76, 1
    s_lshl_b32 s96, s96, 7
    s_add_u32 s97, s97, s96
    s_add_u32 s95, s90, 49152
    s_mov_b32 s90, 851968
    s_lshl2_add_u32 s94, s2, s76
    s_lshl_b32 s94, s94, 7
    v_lshlrev_b32 v37, 17, v160
    s_movk_i32 s34, 0x548
    s_mov_b32 s35, s91
    s_waitcnt lgkmcnt(0)
    s_mov_b64 s[20:21], s[6:7]
    s_mov_b64 s[28:29], s[4:5]
    s_mov_b64 s[88:89], s[10:11]
    s_mov_b64 s[32:33], s[8:9]
    buffer_load_dword v29, v36, s[20:23], s81 offen
    buffer_load_dword v31, v36, s[32:35], s81 offen
    s_movk_i32 s34, 0x200
    s_mov_b64 s[32:33], s[12:13]
    buffer_load_dword v32, v36, s[32:35], s81 offen
    s_mov_b64 s[32:33], s[14:15]
    buffer_load_dword v33, v36, s[32:35], s81 offen
    buffer_load_dword v38, v37, s[88:91], s94 offen
    s_mov_b32 s90, s95
    buffer_load_dword v30, v62, s[88:91], s97 offen
    s_mov_b32 s73, m0
    s_mov_b32 m0, s3
    s_nop 0
    buffer_load_dwordx4 v164, s[28:31], s43 offen nt lds
    buffer_load_dwordx4 v164, s[28:31], s43 offen offset:1024 nt lds
    buffer_load_dwordx4 v164, s[28:31], s43 offen offset:2048 nt lds
    s_mov_b64 exec, 0xffff
    buffer_load_dwordx4 v164, s[28:31], s43 offen offset:3072 nt lds
    s_mov_b64 exec, -1
    s_mov_b32 m0, s73
    s_cmp_eq_u32 s76, 3
    s_cbranch_scc1 L_rest
    s_mov_b64 exec, 0
    s_cmp_eq_u32 s76, 0
    s_cbranch_scc1 L_hop0
    s_cmp_eq_u32 s76, 1
    s_cbranch_scc1 L_hop1
    s_branch L_hop2
.p2align 12
L_rest:
L_hopback:
    s_mov_b64 exec, -1
    s_load_dwordx4 s[84:87], s[0:1], 64
    s_add_u32 s97, s97, 49152
    s_cmp_eq_u32 s76, 2
    s_cselect_b32 s32, s12, s14
    s_cselect_b32 s33, s13, s15
    s_cmp_lt_u32 s76, 2
    s_cselect_b32 s32, s8, s32
    s_cselect_b32 s33, s9, s33
    s_mov_b32 s34, 512
    s_cselect_b32 s34, 1352, s34
    s_mov_b32 s35, 0x20000
    s_cmp_eq_u32 s76, 1
    s_cselect_b32 s43, 1024, 0
    s_mov_b32 s73, m0
    s_add_u32 m0, s47, 1024
    v_and_b32 v161, 15, v160
    buffer_load_dwordx4 v164, s[32:35], s43 offen lds
    s_mov_b32 m0, s73
    v_lshrrev_b32 v162, 4, v160
    buffer_load_dwordx4 v163, s[20:23], s72 offen lds
    s_add_u32 m0, m0, s69
    s_nop 0
    buffer_load_dwordx4 v171, s[20:23], s72 offen lds
    s_add_u32 m0, m0, s70
    s_add_u32 s72, s72, s71
    s_lshl_b32 s68, s2, 10
    s_lshl_b32 s67, s76, 8
    s_add_u32 s68, s68, s67
    s_xor_b32 s67, s68, 1024
    v_mov_b32 v165, s68
    v_mov_b32 v166, s67
    v_cmp_eq_u32 vcc, 0, v162
    v_mov_b32 v167, 0x7fff0000
    s_mov_b32 s46, 262144
    v_cndmask_b32 v52, v166, v165, vcc
    v_cndmask_b32 v54, v167, v166, vcc
    v_cmp_gt_u32 vcc, 2, v162
    v_lshl_add_u32 v54, v161, 2, v54
    s_mov_b32 s47, 0x20000
    buffer_load_dwordx4 v163, s[20:23], s72 offen lds
    s_add_u32 m0, m0, s69
    s_nop 0
    buffer_load_dwordx4 v171, s[20:23], s72 offen lds
    s_add_u32 m0, m0, s70
    s_add_u32 s72, s72, s71
    v_cndmask_b32 v52, v167, v52, vcc
    v_lshl_add_u32 v52, v161, 3, v52
    v_cmp_eq_u32 vcc, 1, v162
    v_lshlrev_b32 v2, 4, v162
    v_add_u32 v2, 19456, v2
    v_cndmask_b32 v55, v167, v165, vcc
    v_lshl_add_u32 v55, v161, 2, v55
    v_lshlrev_b32 v1, 12, v162
    v_lshl_add_u32 v1, v161, 4, v1
    s_mov_b32 s74, 0x05040100
    s_mov_b32 s75, 0x07060302
    s_mov_b64 s[24:25], s[10:11]
    s_mov_b32 s26, 851968
    s_mov_b32 s27, 0x20000
    buffer_load_dwordx4 v163, s[20:23], s72 offen lds
    s_add_u32 m0, m0, s69
    s_nop 0
    buffer_load_dwordx4 v171, s[20:23], s72 offen lds
    s_add_u32 m0, m0, s70
    s_add_u32 s72, s72, s71
    s_load_dword s80, s[16:17], 0
    s_mov_b64 s[36:37], s[18:19]
    s_mov_b32 s38, 32768
    s_mov_b32 s39, 0x20000
    v_mul_u32_u24 v165, 104, v161
    s_mul_i32 s66, s77, 52
    s_add_u32 s66, s66, 5120
    s_mul_i32 s65, s42, 6656
    s_sub_u32 s64, 6656, s65
    s_mul_i32 s63, s76, 1664
    s_xor_b32 s62, s76, 2
    s_mul_i32 s62, s62, 1664
    s_add_u32 s61, s64, s63
    s_add_u32 s61, s61, s66
    buffer_load_dwordx4 v163, s[20:23], s72 offen lds
    s_add_u32 m0, m0, s69
    s_nop 0
    buffer_load_dwordx4 v171, s[20:23], s72 offen lds
    s_add_u32 m0, m0, s70
    s_add_u32 s72, s72, s71
    v_add_u32 v3, s61, v165
    s_add_u32 s61, s65, s63
    s_add_u32 s61, s61, s66
    v_add_u32 v4, s61, v165
    s_add_u32 s61, s64, s62
    s_add_u32 s61, s61, s66
    v_add_u32 v5, s61, v165
    s_add_u32 s61, s65, s62
    s_add_u32 s61, s61, s66
    v_add_u32 v6, s61, v165
    s_add_u32 s61, s65, s63
    s_add_u32 s61, s61, 5120
    v_lshl_add_u32 v46, v161, 2, s61
    v_add_u32 v47, 832, v46
    buffer_load_dwordx4 v163, s[20:23], s72 offen lds
    s_add_u32 m0, m0, s69
    s_nop 0
    buffer_load_dwordx4 v171, s[20:23], s72 offen lds
    s_add_u32 m0, m0, s70
    s_add_u32 s72, s72, s71
    v_cmp_gt_u32 vcc, 13, v161
    v_mov_b32 v166, 64
    v_add_u32 v167, 64000, v2
    v_cndmask_b32 v44, 0, v166, vcc
    v_cndmask_b32 v45, v167, v2, vcc
    v_add_u32 v167, 19456, v164
    s_lshl_b32 s61, s76, 14
    v_add_u32 v56, s61, v167
    s_xor_b32 s61, s61, 32768
    v_add_u32 v57, s61, v167
    v_and_b32 v166, 1, v162
    v_lshrrev_b32 v167, 1, v162
    v_lshl_add_u32 v167, v166, 1, v167
    s_lshl_b32 s61, s76, 6
    buffer_load_dwordx4 v163, s[20:23], s72 offen lds
    s_add_u32 m0, m0, s69
    s_nop 0
    buffer_load_dwordx4 v171, s[20:23], s72 offen lds
    s_add_u32 m0, m0, s70
    s_add_u32 s72, s72, s71
    s_add_u32 s61, s61, 512
    v_lshl_add_u32 v59, v167, 2, s61
    v_lshl_add_u32 v58, v161, 2, s61
    v_mov_b32 v60, 0xc0135761
    v_mov_b32 v61, 0xc0135761
    s_mov_b32 s82, 0xbdd2d3e8
    s_mov_b32 s83, 0xbdd2d3e8
    v_lshl_add_u32 v168, v162, 6, s78
    v_mul_u32_u24 v169, 208, v162
    v_lshl_add_u32 v169, v161, 1, v169
    v_mul_u32_u24 v170, 52, v161
    v_lshl_add_u32 v170, v162, 3, v170
    v_lshl_add_u32 v176, v161, 4, s78
    v_cmp_eq_u32 vcc, 0, v162
    buffer_load_dwordx4 v163, s[20:23], s72 offen lds
    s_add_u32 m0, m0, s69
    s_nop 0
    buffer_load_dwordx4 v171, s[20:23], s72 offen lds
    s_add_u32 m0, m0, s70
    s_add_u32 s72, s72, s71
    v_mov_b32 v178, 0x3f80
    v_mov_b32 v141, 0
    v_mov_b32 v142, 0
    v_mov_b32 v143, 0
    v_cndmask_b32 v177, 0, v178, vcc
    v_lshlrev_b32 v178, 16, v177
    v_mov_b32 v16, 0
    v_mov_b32 v17, 0
    v_mov_b32 v18, 0
    v_mov_b32 v19, 0
    v_mov_b32 v20, 0
    v_mov_b32 v21, 0
    v_mov_b32 v22, 0
    v_mov_b32 v23, 0
    buffer_load_dwordx4 v163, s[20:23], s72 offen lds
    s_add_u32 m0, m0, s69
    s_nop 0
    buffer_load_dwordx4 v171, s[20:23], s72 offen lds
    s_add_u32 m0, m0, s70
    s_add_u32 s72, s72, s71
    v_mov_b32 v24, 0
    v_mov_b32 v25, 0
    v_mov_b32 v26, 0
    v_mov_b32 v27, 0
    v_mov_b32 v172, 0
    v_mov_b32 v173, 0
    v_mov_b32 v174, 0
    v_mov_b32 v175, 0
    s_waitcnt lgkmcnt(0)
    s_lshl_b32 s80, s80, 16
    s_mov_b64 s[44:45], s[86:87]
    s_waitcnt vmcnt(16)
    s_barrier
    buffer_load_dwordx4 v163, s[20:23], s72 offen lds
    s_add_u32 m0, m0, s69
    s_nop 0
    buffer_load_dwordx4 v171, s[20:23], s72 offen lds
    s_add_u32 m0, m0, s70
    s_add_u32 s72, s72, s71
    ds_read_b128 v[136:139], v176 offset:3072
    ds_read2_b32 v[8:9], v3 offset0:0 offset1:1
    ds_read2_b32 v[10:11], v4 offset0:0 offset1:1
    ds_read2_b32 v[12:13], v5 offset0:0 offset1:1
    ds_read2_b32 v[14:15], v6 offset0:0 offset1:1
    ds_read2_b32 v[128:129], v46 offset0:0 offset1:13
    v_mov_b32 v140, v177
    ds_read_u16_d16_hi v16, v169 offset:1024
    buffer_load_dwordx4 v163, s[20:23], s72 offen lds
    s_add_u32 m0, m0, s69
    s_nop 0
    buffer_load_dwordx4 v171, s[20:23], s72 offen lds
    s_add_u32 m0, m0, s70
    s_add_u32 s72, s72, s71
    ds_read_u16_d16_hi v20, v169 offset:1050
    s_waitcnt lgkmcnt(7)
    v_mfma_f32_16x16x32_bf16 v[64:67], v[136:139], v[140:143], 0
    v_mfma_f32_16x16x32_bf16 v[96:99], v[136:139], v[140:143], 0
    v_mov_b32 v140, v178
    ds_read_u16_d16_hi v24, v169 offset:1726
    ds_read_u16_d16_hi v172, v170 offset:1700
    v_mfma_f32_16x16x32_bf16 v[68:71], v[136:139], v[140:143], 0
    v_mfma_f32_16x16x32_bf16 v[100:103], v[136:139], v[140:143], 0
    buffer_load_dwordx4 v163, s[20:23], s72 offen lds
    s_add_u32 m0, m0, s69
    s_nop 0
    buffer_load_dwordx4 v171, s[20:23], s72 offen lds
    s_add_u32 m0, m0, s70
    s_add_u32 s72, s72, s71
    s_waitcnt lgkmcnt(8)
    v_lshl_add_u32 v8, v8, 6, v2
    v_lshl_add_u32 v9, v9, 6, v2
    s_waitcnt lgkmcnt(7)
    v_lshl_add_u32 v10, v10, 6, v2
    v_lshl_add_u32 v11, v11, 6, v2
    s_waitcnt lgkmcnt(6)
    v_lshl_add_u32 v12, v12, 6, v2
    v_lshl_add_u32 v13, v13, 6, v2
    s_waitcnt lgkmcnt(5)
    v_lshl_add_u32 v14, v14, 6, v2
    v_lshl_add_u32 v15, v15, 6, v2
    buffer_load_dwordx4 v163, s[20:23], s72 offen lds
    s_add_u32 m0, m0, s69
    s_nop 0
    buffer_load_dwordx4 v171, s[20:23], s72 offen lds
    s_add_u32 m0, m0, s70
    s_add_u32 s72, s72, s71
    v_mov_b32 v141, v177
    v_mov_b32 v140, 0
    ds_read_u16_d16_hi v17, v169 offset:1076
    ds_read_u16_d16_hi v21, v169 offset:1102
    v_mfma_f32_16x16x32_bf16 v[72:75], v[136:139], v[140:143], 0
    v_mfma_f32_16x16x32_bf16 v[104:107], v[136:139], v[140:143], 0
    v_mov_b32 v141, v178
    ds_read_u16_d16_hi v25, v169 offset:1778
    buffer_load_dwordx4 v163, s[20:23], s72 offen lds
    s_add_u32 m0, m0, s69
    s_nop 0
    buffer_load_dwordx4 v171, s[20:23], s72 offen lds
    s_add_u32 m0, m0, s70
    s_add_u32 s72, s72, s71
    ds_read_u16_d16_hi v173, v170 offset:1702
    v_mfma_f32_16x16x32_bf16 v[76:79], v[136:139], v[140:143], 0
    v_mfma_f32_16x16x32_bf16 v[108:111], v[136:139], v[140:143], 0
    s_waitcnt lgkmcnt(6)
    v_mad_u32_u24 v128, v128, v44, v45
    v_mad_u32_u24 v129, v129, v44, v45
    ds_read_b64 a[160:161], v168 offset:4096
    ds_read_b64 a[162:163], v168 offset:4112
    ds_read_b64 a[164:165], v168 offset:4128
    buffer_load_dwordx4 v163, s[20:23], s72 offen lds
    s_add_u32 m0, m0, s69
    s_nop 0
    buffer_load_dwordx4 v171, s[20:23], s72 offen lds
    s_add_u32 m0, m0, s70
    s_add_u32 s72, s72, s71
    ds_read_b64 a[166:167], v168 offset:4144
    ds_read_b64 a[168:169], v168 offset:4104
    ds_read_b64 a[170:171], v168 offset:4120
    ds_read_b64 a[172:173], v168 offset:4136
    ds_read_b64 a[174:175], v168 offset:4152
    v_mov_b32 v142, v177
    v_mov_b32 v141, 0
    ds_read_u16_d16_hi v18, v169 offset:1128
    buffer_load_dwordx4 v163, s[20:23], s72 offen lds
    s_add_u32 m0, m0, s69
    s_nop 0
    buffer_load_dwordx4 v171, s[20:23], s72 offen lds
    s_add_u32 m0, m0, s70
    s_add_u32 s72, s72, s71
    ds_read_u16_d16_hi v22, v169 offset:1154
    v_mfma_f32_16x16x32_bf16 v[80:83], v[136:139], v[140:143], 0
    v_mfma_f32_16x16x32_bf16 v[112:115], v[136:139], v[140:143], 0
    v_mov_b32 v142, v178
    ds_read_u16_d16_hi v26, v169 offset:1830
    ds_read_u16_d16_hi v174, v170 offset:1704
    v_mfma_f32_16x16x32_bf16 v[84:87], v[136:139], v[140:143], 0
    v_mfma_f32_16x16x32_bf16 v[116:119], v[136:139], v[140:143], 0
    s_cmp_eq_u32 s76, 3
    s_cselect_b32 s41, 1024, 0
    s_sub_u32 m0, m0, s41
    s_lshl_b32 s41, s41, 1
    s_sub_u32 s72, s72, s41
    buffer_load_dwordx4 v163, s[20:23], s72 offen lds
    s_add_u32 m0, m0, s69
    s_nop 0
    buffer_load_dwordx4 v171, s[20:23], s72 offen lds
    v_mov_b32 v143, v177
    v_mov_b32 v142, 0
    ds_read_u16_d16_hi v19, v169 offset:1180
    ds_read_u16_d16_hi v23, v169 offset:1206
    v_mfma_f32_16x16x32_bf16 v[88:91], v[136:139], v[140:143], 0
    v_mfma_f32_16x16x32_bf16 v[120:123], v[136:139], v[140:143], 0
    v_mov_b32 v143, v178
    ds_read_u16_d16_hi v27, v169 offset:1882
    buffer_load_dwordx4 v[192:195], v1, s[24:27], s48 offen
    buffer_load_dwordx4 v[196:199], v1, s[24:27], s48 offen offset:512
    ds_read_u16_d16_hi v175, v170 offset:1706
    v_mfma_f32_16x16x32_bf16 v[92:95], v[136:139], v[140:143], 0
    v_mfma_f32_16x16x32_bf16 v[124:127], v[136:139], v[140:143], 0
    s_waitcnt lgkmcnt(13)
    v_add_f32 v20, v20, v172
    v_add_f32 v21, v21, v173
    s_waitcnt lgkmcnt(4)
    v_add_f32 v22, v22, v174
    s_waitcnt lgkmcnt(0)
    v_add_f32 v23, v23, v175
    s_movk_i32 s96, 0x4000
    buffer_load_dwordx4 v[200:203], v1, s[24:27], s48 offen offset:1024
    buffer_load_dwordx4 v[204:207], v1, s[24:27], s48 offen offset:1536
    s_add_u32 s49, s48, s96
    s_add_u32 s50, s49, s96
    s_add_u32 s51, s50, s96
    s_add_u32 s52, s51, s96
    s_add_u32 s53, s52, s96
    s_add_u32 s54, s53, s96
    s_add_u32 s55, s54, s96
    s_add_u32 s56, s55, s96
    buffer_load_dwordx4 v[208:211], v1, s[24:27], s48 offen offset:2048
    buffer_load_dwordx4 v[212:215], v1, s[24:27], s48 offen offset:2560
    s_add_u32 s57, s56, s96
    s_add_u32 s58, s57, s96
    s_add_u32 s59, s58, s96
    s_add_u32 s60, s59, s96
    buffer_load_dwordx4 v[216:219], v1, s[24:27], s48 offen offset:3072
    buffer_load_dwordx4 v[220:223], v1, s[24:27], s48 offen offset:3584
    s_add_u32 s61, s60, s96
    s_add_u32 s62, s61, s96
    s_add_u32 s63, s62, s96
    s_add_u32 s64, s63, s96
    s_add_u32 s65, s64, s96
    s_add_u32 s66, s65, s96
    s_add_u32 s67, s66, s96
    s_add_u32 s68, s67, s96
    s_add_u32 s69, s68, s96
    s_add_u32 s70, s69, s96
    s_add_u32 s71, s70, s96
    s_add_u32 s72, s71, s96
    s_add_u32 s73, s72, s96
    s_waitcnt lgkmcnt(0)
    s_waitcnt vmcnt(8)
    s_barrier
    ds_read_b128 a[96:99], v128
    ds_read_b128 a[100:103], v128 offset:64512
    ds_read_b128 a[104:107], v129
    ds_read_b128 a[108:111], v129 offset:64512
    ds_read_b128 a[64:67], v8
    ds_read_b128 a[68:71], v10
    ds_read_b128 a[72:75], v12
    ds_read_b128 a[76:79], v14
    s_nop 0
    s_waitcnt vmcnt(4)
    v_perm_b32 v128, v196, v192, s74
    v_perm_b32 v132, v196, v192, s75
    v_perm_b32 v136, v197, v193, s74
    v_perm_b32 v140, v197, v193, s75
    v_perm_b32 v144, v198, v194, s74
    v_perm_b32 v148, v198, v194, s75
    v_perm_b32 v152, v199, v195, s74
    v_perm_b32 v156, v199, v195, s75
    buffer_load_dwordx4 v[224:227], v1, s[24:27], s49 offen
    buffer_load_dwordx4 v[228:231], v1, s[24:27], s49 offen offset:512
    v_perm_b32 v129, v204, v200, s74
    v_perm_b32 v133, v204, v200, s75
    v_perm_b32 v137, v205, v201, s74
    v_perm_b32 v141, v205, v201, s75
    v_perm_b32 v145, v206, v202, s74
    v_perm_b32 v149, v206, v202, s75
    s_waitcnt lgkmcnt(7)
    v_mfma_f32_16x16x32_bf16 v[28:31], a[96:99], a[96:99], 0
    buffer_load_dwordx4 v[232:235], v1, s[24:27], s49 offen offset:1024
    v_perm_b32 v153, v207, v203, s74
    v_perm_b32 v157, v207, v203, s75
    buffer_load_dwordx4 v[236:239], v1, s[24:27], s49 offen offset:1536
    s_waitcnt lgkmcnt(6)
    v_mfma_f32_16x16x32_bf16 v[28:31], a[100:103], a[100:103], v[28:31]
    s_waitcnt vmcnt(4)
    v_perm_b32 v130, v212, v208, s74
    v_perm_b32 v134, v212, v208, s75
    v_perm_b32 v138, v213, v209, s74
    v_perm_b32 v142, v213, v209, s75
    v_perm_b32 v146, v214, v210, s74
    v_perm_b32 v150, v214, v210, s75
    s_waitcnt lgkmcnt(5)
    v_mfma_f32_16x16x32_bf16 v[32:35], a[96:99], a[104:107], 0
    buffer_load_dwordx4 v[240:243], v1, s[24:27], s49 offen offset:2048
    v_perm_b32 v154, v215, v211, s74
    v_perm_b32 v158, v215, v211, s75
    buffer_load_dwordx4 v[244:247], v1, s[24:27], s49 offen offset:2560
    s_waitcnt lgkmcnt(4)
    v_mfma_f32_16x16x32_bf16 v[32:35], a[100:103], a[108:111], v[32:35]
    v_perm_b32 v131, v220, v216, s74
    v_perm_b32 v135, v220, v216, s75
    v_perm_b32 v139, v221, v217, s74
    v_perm_b32 v143, v221, v217, s75
    v_perm_b32 v147, v222, v218, s74
    v_perm_b32 v151, v222, v218, s75
    v_mfma_f32_16x16x32_bf16 v[36:39], a[104:107], a[104:107], 0
    buffer_load_dwordx4 v[248:251], v1, s[24:27], s49 offen offset:3072
    v_perm_b32 v155, v223, v219, s74
    v_perm_b32 v159, v223, v219, s75
    buffer_load_dwordx4 v[252:255], v1, s[24:27], s49 offen offset:3584
    v_mfma_f32_16x16x32_bf16 v[36:39], a[108:111], a[108:111], v[36:39]
    v_mul_f32 v48, v16, v28
    v_fmac_f32 v48, v17, v29
    v_fmac_f32 v48, v18, v30
    v_fmac_f32 v48, v19, v31
    v_fmac_f32 v48, v20, v32
    v_fmac_f32 v48, v21, v33
    s_waitcnt lgkmcnt(0)
    v_mfma_f32_16x16x32_bf16 v[64:67], v[128:131], a[64:67], v[64:67]
    v_fmac_f32 v48, v22, v34
    v_fmac_f32 v48, v23, v35
    v_mfma_f32_16x16x32_bf16 v[68:71], v[132:135], a[64:67], v[68:71]
    v_fmac_f32 v48, v24, v36
    v_fmac_f32 v48, v25, v37
    v_mfma_f32_16x16x32_bf16 v[72:75], v[136:139], a[64:67], v[72:75]
    buffer_load_dwordx4 v[192:195], v1, s[24:27], s50 offen
    v_mfma_f32_16x16x32_bf16 v[76:79], v[140:143], a[64:67], v[76:79]
    ds_read_b128 a[80:83], v8 offset:64512
    ds_read2_b32 v[42:43], v46 offset0:26 offset1:39
    v_mfma_f32_16x16x32_bf16 v[80:83], v[144:147], a[64:67], v[80:83]
    v_fmac_f32 v48, v26, v38
    v_fmac_f32 v48, v27, v39
    v_mfma_f32_16x16x32_bf16 v[84:87], v[148:151], a[64:67], v[84:87]
    ds_read_b128 a[84:87], v10 offset:64512
    v_mfma_f32_16x16x32_bf16 v[88:91], v[152:155], a[64:67], v[88:91]
    buffer_load_dwordx4 v[196:199], v1, s[24:27], s50 offen offset:512
    v_mfma_f32_16x16x32_bf16 v[92:95], v[156:159], a[64:67], v[92:95]
    v_mfma_f32_16x16x32_bf16 v[124:127], v[156:159], a[68:71], v[124:127]
    ds_read_b128 a[88:91], v12 offset:64512
    v_mfma_f32_16x16x32_bf16 v[120:123], v[152:155], a[68:71], v[120:123]
    s_waitcnt vmcnt(6)
    v_perm_b32 v160, v228, v224, s74
    v_perm_b32 v164, v228, v224, s75
    v_mfma_f32_16x16x32_bf16 v[116:119], v[148:151], a[68:71], v[116:119]
    buffer_load_dwordx4 v[200:203], v1, s[24:27], s50 offen offset:1024
    v_mfma_f32_16x16x32_bf16 v[112:115], v[144:147], a[68:71], v[112:115]
    v_perm_b32 v168, v229, v225, s74
    v_perm_b32 v172, v229, v225, s75
    v_mfma_f32_16x16x32_bf16 v[108:111], v[140:143], a[68:71], v[108:111]
    v_perm_b32 v176, v230, v226, s74
    v_perm_b32 v180, v230, v226, s75
    v_mfma_f32_16x16x32_bf16 v[104:107], v[136:139], a[68:71], v[104:107]
    v_perm_b32 v184, v231, v227, s74
    v_perm_b32 v188, v231, v227, s75
    v_mfma_f32_16x16x32_bf16 v[100:103], v[132:135], a[68:71], v[100:103]
    buffer_load_dwordx4 v[204:207], v1, s[24:27], s50 offen offset:1536
    v_mfma_f32_16x16x32_bf16 v[96:99], v[128:131], a[68:71], v[96:99]
    ds_read_b128 a[92:95], v14 offset:64512
    s_waitcnt lgkmcnt(3)
    v_mad_u32_u24 v42, v42, v44, v45
    v_mfma_f32_16x16x32_bf16 a[0:3], v[128:131], a[72:75], 0
    v_mad_u32_u24 v43, v43, v44, v45
    v_perm_b32 v161, v236, v232, s74
    v_mfma_f32_16x16x32_bf16 a[4:7], v[132:135], a[72:75], 0
    v_perm_b32 v165, v236, v232, s75
    v_perm_b32 v169, v237, v233, s74
    v_mfma_f32_16x16x32_bf16 a[8:11], v[136:139], a[72:75], 0
    buffer_load_dwordx4 v[208:211], v1, s[24:27], s50 offen offset:2048
    v_mfma_f32_16x16x32_bf16 a[12:15], v[140:143], a[72:75], 0
    v_perm_b32 v173, v237, v233, s75
    v_perm_b32 v177, v238, v234, s74
    v_mfma_f32_16x16x32_bf16 a[16:19], v[144:147], a[72:75], 0
    v_perm_b32 v181, v238, v234, s75
    v_perm_b32 v185, v239, v235, s74
    v_mfma_f32_16x16x32_bf16 a[20:23], v[148:151], a[72:75], 0
    v_perm_b32 v189, v239, v235, s75
    s_waitcnt vmcnt(5)
    v_perm_b32 v162, v244, v240, s74
    v_mfma_f32_16x16x32_bf16 a[24:27], v[152:155], a[72:75], 0
    buffer_load_dwordx4 v[212:215], v1, s[24:27], s50 offen offset:2560
    v_mfma_f32_16x16x32_bf16 a[28:31], v[156:159], a[72:75], 0
    ds_read_b128 a[112:115], v42
    v_perm_b32 v166, v244, v240, s75
    v_mfma_f32_16x16x32_bf16 a[60:63], v[156:159], a[76:79], 0
    v_perm_b32 v170, v245, v241, s74
    v_perm_b32 v174, v245, v241, s75
    v_mfma_f32_16x16x32_bf16 a[56:59], v[152:155], a[76:79], 0
    ds_read_b128 a[116:119], v42 offset:64512
    v_perm_b32 v178, v246, v242, s74
    v_mfma_f32_16x16x32_bf16 a[52:55], v[148:151], a[76:79], 0
    buffer_load_dwordx4 v[216:219], v1, s[24:27], s50 offen offset:3072
    v_mfma_f32_16x16x32_bf16 a[48:51], v[144:147], a[76:79], 0
    v_perm_b32 v182, v246, v242, s75
    v_perm_b32 v186, v247, v243, s74
    v_mfma_f32_16x16x32_bf16 a[44:47], v[140:143], a[76:79], 0
    v_perm_b32 v190, v247, v243, s75
    v_perm_b32 v163, v252, v248, s74
    v_mfma_f32_16x16x32_bf16 a[40:43], v[136:139], a[76:79], 0
    ds_read_b128 a[120:123], v43
    v_perm_b32 v167, v252, v248, s75
    v_mfma_f32_16x16x32_bf16 a[36:39], v[132:135], a[76:79], 0
    buffer_load_dwordx4 v[220:223], v1, s[24:27], s50 offen offset:3584
    v_mfma_f32_16x16x32_bf16 a[32:35], v[128:131], a[76:79], 0
    ds_read_b128 a[124:127], v43 offset:64512
    v_perm_b32 v171, v253, v249, s74
    v_mfma_f32_16x16x32_bf16 v[64:67], v[160:163], a[80:83], v[64:67]
    v_perm_b32 v175, v253, v249, s75
    v_perm_b32 v179, v254, v250, s74
    v_mfma_f32_16x16x32_bf16 v[68:71], v[164:167], a[80:83], v[68:71]
    v_perm_b32 v183, v254, v250, s75
    v_perm_b32 v187, v255, v251, s74
    v_mfma_f32_16x16x32_bf16 v[72:75], v[168:171], a[80:83], v[72:75]
    buffer_load_dwordx4 v[224:227], v1, s[24:27], s51 offen
    v_mfma_f32_16x16x32_bf16 v[76:79], v[172:175], a[80:83], v[76:79]
    ds_read_b128 a[64:67], v9
    v_perm_b32 v191, v255, v251, s75
    v_mfma_f32_16x16x32_bf16 v[80:83], v[176:179], a[80:83], v[80:83]
    s_waitcnt vmcnt(5)
    v_perm_b32 v128, v196, v192, s74
    v_perm_b32 v132, v196, v192, s75
    v_mfma_f32_16x16x32_bf16 v[84:87], v[180:183], a[80:83], v[84:87]
    v_perm_b32 v136, v197, v193, s74
    v_perm_b32 v140, v197, v193, s75
    v_mfma_f32_16x16x32_bf16 v[88:91], v[184:187], a[80:83], v[88:91]
    buffer_load_dwordx4 v[228:231], v1, s[24:27], s51 offen offset:512
    v_mfma_f32_16x16x32_bf16 v[92:95], v[188:191], a[80:83], v[92:95]
    v_perm_b32 v144, v198, v194, s74
    v_perm_b32 v148, v198, v194, s75
    s_waitcnt lgkmcnt(3)
    v_mfma_f32_16x16x32_bf16 v[124:127], v[188:191], a[84:87], v[124:127]
    ds_read_b128 a[68:71], v11
    v_perm_b32 v152, v199, v195, s74
    v_mfma_f32_16x16x32_bf16 v[120:123], v[184:187], a[84:87], v[120:123]
    ds_read2_b32 v[40:41], v46 offset0:52 offset1:65
    v_perm_b32 v156, v199, v195, s75
    v_mfma_f32_16x16x32_bf16 v[116:119], v[180:183], a[84:87], v[116:119]
    buffer_load_dwordx4 v[232:235], v1, s[24:27], s51 offen offset:1024
    v_mfma_f32_16x16x32_bf16 v[112:115], v[176:179], a[84:87], v[112:115]
    ds_read_b128 a[72:75], v13
    v_perm_b32 v129, v204, v200, s74
    v_mfma_f32_16x16x32_bf16 v[108:111], v[172:175], a[84:87], v[108:111]
    v_perm_b32 v133, v204, v200, s75
    v_perm_b32 v137, v205, v201, s74
    v_mfma_f32_16x16x32_bf16 v[104:107], v[168:171], a[84:87], v[104:107]
    ds_read_b128 a[76:79], v15
    v_perm_b32 v141, v205, v201, s75
    v_mfma_f32_16x16x32_bf16 v[100:103], v[164:167], a[84:87], v[100:103]
    buffer_load_dwordx4 v[236:239], v1, s[24:27], s51 offen offset:1536
    v_mfma_f32_16x16x32_bf16 v[96:99], v[160:163], a[84:87], v[96:99]
    v_perm_b32 v145, v206, v202, s74
    v_perm_b32 v149, v206, v202, s75
    v_mfma_f32_16x16x32_bf16 v[28:31], a[112:115], a[112:115], 0
    v_perm_b32 v153, v207, v203, s74
    v_perm_b32 v157, v207, v203, s75
    v_mfma_f32_16x16x32_bf16 v[28:31], a[116:119], a[116:119], v[28:31]
    s_waitcnt lgkmcnt(4)
    v_mfma_f32_16x16x32_bf16 v[32:35], a[112:115], a[120:123], 0
    buffer_load_dwordx4 v[240:243], v1, s[24:27], s51 offen offset:2048
    v_mfma_f32_16x16x32_bf16 v[32:35], a[116:119], a[124:127], v[32:35]
    s_waitcnt lgkmcnt(2)
    v_mad_u32_u24 v40, v40, v44, v45
    v_mad_u32_u24 v41, v41, v44, v45
    v_mfma_f32_16x16x32_bf16 v[36:39], a[120:123], a[120:123], 0
    s_waitcnt vmcnt(5)
    v_perm_b32 v130, v212, v208, s74
    v_perm_b32 v134, v212, v208, s75
    v_mfma_f32_16x16x32_bf16 v[36:39], a[124:127], a[124:127], v[36:39]
    v_perm_b32 v138, v213, v209, s74
    v_perm_b32 v142, v213, v209, s75
    v_mfma_f32_16x16x32_bf16 a[0:3], v[160:163], a[88:91], a[0:3]
    buffer_load_dwordx4 v[244:247], v1, s[24:27], s51 offen offset:2560
    v_mfma_f32_16x16x32_bf16 a[4:7], v[164:167], a[88:91], a[4:7]
    v_perm_b32 v146, v214, v210, s74
    v_perm_b32 v150, v214, v210, s75
    v_mfma_f32_16x16x32_bf16 a[8:11], v[168:171], a[88:91], a[8:11]
    v_perm_b32 v154, v215, v211, s74
    v_perm_b32 v158, v215, v211, s75
    v_mfma_f32_16x16x32_bf16 a[12:15], v[172:175], a[88:91], a[12:15]
    ds_read_b128 a[96:99], v40
    v_mul_f32 v49, v16, v28
    v_mfma_f32_16x16x32_bf16 a[16:19], v[176:179], a[88:91], a[16:19]
    buffer_load_dwordx4 v[248:251], v1, s[24:27], s51 offen offset:3072
    v_mfma_f32_16x16x32_bf16 a[20:23], v[180:183], a[88:91], a[20:23]
    ds_read_b128 a[100:103], v40 offset:64512
    v_perm_b32 v131, v220, v216, s74
    v_mfma_f32_16x16x32_bf16 a[24:27], v[184:187], a[88:91], a[24:27]
    v_perm_b32 v135, v220, v216, s75
    v_perm_b32 v139, v221, v217, s74
    v_mfma_f32_16x16x32_bf16 a[28:31], v[188:191], a[88:91], a[28:31]
    v_perm_b32 v143, v221, v217, s75
    v_perm_b32 v147, v222, v218, s74
    v_mfma_f32_16x16x32_bf16 a[60:63], v[188:191], a[92:95], a[60:63]
    buffer_load_dwordx4 v[252:255], v1, s[24:27], s51 offen offset:3584
    v_mfma_f32_16x16x32_bf16 a[56:59], v[184:187], a[92:95], a[56:59]
    v_perm_b32 v151, v222, v218, s75
    v_perm_b32 v155, v223, v219, s74
    v_mfma_f32_16x16x32_bf16 a[52:55], v[180:183], a[92:95], a[52:55]
    ds_read_b128 a[104:107], v41
    v_perm_b32 v159, v223, v219, s75
    v_mfma_f32_16x16x32_bf16 a[48:51], v[176:179], a[92:95], a[48:51]
    v_fmac_f32 v49, v17, v29
    v_fmac_f32 v49, v18, v30
    v_mfma_f32_16x16x32_bf16 a[44:47], v[172:175], a[92:95], a[44:47]
    buffer_load_dwordx4 v[192:195], v1, s[24:27], s52 offen
    v_mfma_f32_16x16x32_bf16 a[40:43], v[168:171], a[92:95], a[40:43]
    ds_read_b128 a[108:111], v41 offset:64512
    v_fmac_f32 v49, v19, v31
    v_mfma_f32_16x16x32_bf16 a[36:39], v[164:167], a[92:95], a[36:39]
    v_fmac_f32 v49, v20, v32
    v_fmac_f32 v49, v21, v33
    v_mfma_f32_16x16x32_bf16 a[32:35], v[160:163], a[92:95], a[32:35]
    v_fmac_f32 v49, v22, v34
    v_fmac_f32 v49, v23, v35
    v_mfma_f32_16x16x32_bf16 v[64:67], v[128:131], a[64:67], v[64:67]
    buffer_load_dwordx4 v[196:199], v1, s[24:27], s52 offen offset:512
    v_mfma_f32_16x16x32_bf16 v[68:71], v[132:135], a[64:67], v[68:71]
    v_fmac_f32 v49, v24, v36
    v_fmac_f32 v49, v25, v37
    v_mfma_f32_16x16x32_bf16 v[72:75], v[136:139], a[64:67], v[72:75]
    ds_read_b128 a[80:83], v9 offset:64512
    v_fmac_f32 v49, v26, v38
    v_mfma_f32_16x16x32_bf16 v[76:79], v[140:143], a[64:67], v[76:79]
    v_fmac_f32 v49, v27, v39
    s_waitcnt vmcnt(6)
    v_perm_b32 v160, v228, v224, s74
    v_mfma_f32_16x16x32_bf16 v[80:83], v[144:147], a[64:67], v[80:83]
    buffer_load_dwordx4 v[200:203], v1, s[24:27], s52 offen offset:1024
    v_mfma_f32_16x16x32_bf16 v[84:87], v[148:151], a[64:67], v[84:87]
    v_perm_b32 v164, v228, v224, s75
    v_perm_b32 v168, v229, v225, s74
    v_mfma_f32_16x16x32_bf16 v[88:91], v[152:155], a[64:67], v[88:91]
    v_perm_b32 v172, v229, v225, s75
    v_perm_b32 v176, v230, v226, s74
    v_mfma_f32_16x16x32_bf16 v[92:95], v[156:159], a[64:67], v[92:95]
    v_perm_b32 v180, v230, v226, s75
    v_perm_b32 v184, v231, v227, s74
    v_mfma_f32_16x16x32_bf16 v[124:127], v[156:159], a[68:71], v[124:127]
L_hop0:
    s_cbranch_execz L_hop3
    buffer_load_dwordx4 v[204:207], v1, s[24:27], s52 offen offset:1536
    v_mfma_f32_16x16x32_bf16 v[120:123], v[152:155], a[68:71], v[120:123]
    ds_read_b128 a[84:87], v11 offset:64512
    v_perm_b32 v188, v231, v227, s75
    v_mfma_f32_16x16x32_bf16 v[116:119], v[148:151], a[68:71], v[116:119]
    ds_read2_b32 v[8:9], v3 offset0:2 offset1:3
    ds_read2_b32 v[10:11], v4 offset0:2 offset1:3
    v_mfma_f32_16x16x32_bf16 v[112:115], v[144:147], a[68:71], v[112:115]
    ds_read_b128 a[88:91], v13 offset:64512
    ds_read2_b32 v[12:13], v5 offset0:2 offset1:3
    v_mfma_f32_16x16x32_bf16 v[108:111], v[140:143], a[68:71], v[108:111]
    buffer_load_dwordx4 v[208:211], v1, s[24:27], s52 offen offset:2048
    v_mfma_f32_16x16x32_bf16 v[104:107], v[136:139], a[68:71], v[104:107]
    ds_read_b128 a[92:95], v15 offset:64512
    ds_read2_b32 v[14:15], v6 offset0:2 offset1:3
    v_mfma_f32_16x16x32_bf16 v[100:103], v[132:135], a[68:71], v[100:103]
    v_perm_b32 v161, v236, v232, s74
    v_perm_b32 v165, v236, v232, s75
    v_mfma_f32_16x16x32_bf16 v[96:99], v[128:131], a[68:71], v[96:99]
    v_perm_b32 v169, v237, v233, s74
    v_perm_b32 v173, v237, v233, s75
    s_waitcnt lgkmcnt(8)
    v_mfma_f32_16x16x32_bf16 v[28:31], a[96:99], a[96:99], 0
    buffer_load_dwordx4 v[212:215], v1, s[24:27], s52 offen offset:2560
    v_mfma_f32_16x16x32_bf16 v[28:31], a[100:103], a[100:103], v[28:31]
    v_perm_b32 v177, v238, v234, s74
    v_perm_b32 v181, v238, v234, s75
    v_mfma_f32_16x16x32_bf16 v[32:35], a[96:99], a[104:107], 0
    v_perm_b32 v185, v239, v235, s74
    v_perm_b32 v189, v239, v235, s75
    v_mfma_f32_16x16x32_bf16 v[32:35], a[100:103], a[108:111], v[32:35]
    s_waitcnt vmcnt(6)
    v_perm_b32 v162, v244, v240, s74
    v_perm_b32 v166, v244, v240, s75
    v_mfma_f32_16x16x32_bf16 v[36:39], a[104:107], a[104:107], 0
    buffer_load_dwordx4 v[216:219], v1, s[24:27], s52 offen offset:3072
    v_mfma_f32_16x16x32_bf16 v[36:39], a[108:111], a[108:111], v[36:39]
    v_perm_b32 v170, v245, v241, s74
    v_perm_b32 v174, v245, v241, s75
    v_mfma_f32_16x16x32_bf16 a[0:3], v[128:131], a[72:75], a[0:3]
    v_perm_b32 v178, v246, v242, s74
    v_perm_b32 v182, v246, v242, s75
    v_mfma_f32_16x16x32_bf16 a[4:7], v[132:135], a[72:75], a[4:7]
    v_perm_b32 v186, v247, v243, s74
    v_perm_b32 v190, v247, v243, s75
    v_mfma_f32_16x16x32_bf16 a[8:11], v[136:139], a[72:75], a[8:11]
    buffer_load_dwordx4 v[220:223], v1, s[24:27], s52 offen offset:3584
    v_mfma_f32_16x16x32_bf16 a[12:15], v[140:143], a[72:75], a[12:15]
    s_waitcnt lgkmcnt(3)
    v_lshl_add_u32 v8, v8, 6, v2
    v_lshl_add_u32 v9, v9, 6, v2
    v_mfma_f32_16x16x32_bf16 a[16:19], v[144:147], a[72:75], a[16:19]
    v_mul_f32 v50, v16, v28
    v_fmac_f32 v50, v17, v29
    v_mfma_f32_16x16x32_bf16 a[20:23], v[148:151], a[72:75], a[20:23]
    v_perm_b32 v163, v252, v248, s74
    v_perm_b32 v167, v252, v248, s75
    v_mfma_f32_16x16x32_bf16 a[24:27], v[152:155], a[72:75], a[24:27]
    buffer_load_dwordx4 v[224:227], v1, s[24:27], s53 offen
    v_mfma_f32_16x16x32_bf16 a[28:31], v[156:159], a[72:75], a[28:31]
    v_perm_b32 v171, v253, v249, s74
    v_perm_b32 v175, v253, v249, s75
    v_mfma_f32_16x16x32_bf16 a[60:63], v[156:159], a[76:79], a[60:63]
    v_perm_b32 v179, v254, v250, s74
    v_perm_b32 v183, v254, v250, s75
    v_mfma_f32_16x16x32_bf16 a[56:59], v[152:155], a[76:79], a[56:59]
    v_perm_b32 v187, v255, v251, s74
    v_perm_b32 v191, v255, v251, s75
    v_mfma_f32_16x16x32_bf16 a[52:55], v[148:151], a[76:79], a[52:55]
    buffer_load_dwordx4 v[228:231], v1, s[24:27], s53 offen offset:512
    v_mfma_f32_16x16x32_bf16 a[48:51], v[144:147], a[76:79], a[48:51]
    v_fmac_f32 v50, v18, v30
    v_fmac_f32 v50, v19, v31
    v_mfma_f32_16x16x32_bf16 a[44:47], v[140:143], a[76:79], a[44:47]
    v_lshl_add_u32 v10, v10, 6, v2
    v_lshl_add_u32 v11, v11, 6, v2
    v_mfma_f32_16x16x32_bf16 a[40:43], v[136:139], a[76:79], a[40:43]
    v_fmac_f32 v50, v20, v32
    v_fmac_f32 v50, v21, v33
    v_mfma_f32_16x16x32_bf16 a[36:39], v[132:135], a[76:79], a[36:39]
    buffer_load_dwordx4 v[232:235], v1, s[24:27], s53 offen offset:1024
    v_mfma_f32_16x16x32_bf16 a[32:35], v[128:131], a[76:79], a[32:35]
    v_fmac_f32 v50, v22, v34
    v_fmac_f32 v50, v23, v35
    v_mfma_f32_16x16x32_bf16 v[64:67], v[160:163], a[80:83], v[64:67]
    s_waitcnt lgkmcnt(0)
    v_lshl_add_u32 v12, v12, 6, v2
    v_lshl_add_u32 v13, v13, 6, v2
    v_mfma_f32_16x16x32_bf16 v[68:71], v[164:167], a[80:83], v[68:71]
    s_waitcnt vmcnt(7)
    v_perm_b32 v128, v196, v192, s74
    v_perm_b32 v132, v196, v192, s75
    v_mfma_f32_16x16x32_bf16 v[72:75], v[168:171], a[80:83], v[72:75]
    buffer_load_dwordx4 v[236:239], v1, s[24:27], s53 offen offset:1536
    v_mfma_f32_16x16x32_bf16 v[76:79], v[172:175], a[80:83], v[76:79]
    v_perm_b32 v136, v197, v193, s74
    v_perm_b32 v140, v197, v193, s75
    v_mfma_f32_16x16x32_bf16 v[80:83], v[176:179], a[80:83], v[80:83]
    v_perm_b32 v144, v198, v194, s74
    v_perm_b32 v148, v198, v194, s75
    v_mfma_f32_16x16x32_bf16 v[84:87], v[180:183], a[80:83], v[84:87]
    ds_read_b128 a[64:67], v8
    ds_read2_b32 v[42:43], v46 offset0:78 offset1:91
    v_mfma_f32_16x16x32_bf16 v[88:91], v[184:187], a[80:83], v[88:91]
    buffer_load_dwordx4 v[240:243], v1, s[24:27], s53 offen offset:2048
    v_mfma_f32_16x16x32_bf16 v[92:95], v[188:191], a[80:83], v[92:95]
    v_perm_b32 v152, v199, v195, s74
    v_perm_b32 v156, v199, v195, s75
    v_mfma_f32_16x16x32_bf16 v[124:127], v[188:191], a[84:87], v[124:127]
    ds_read_b128 a[68:71], v10
    v_fmac_f32 v50, v24, v36
    v_mfma_f32_16x16x32_bf16 v[120:123], v[184:187], a[84:87], v[120:123]
    v_fmac_f32 v50, v25, v37
    v_fmac_f32 v50, v26, v38
    v_mfma_f32_16x16x32_bf16 v[116:119], v[180:183], a[84:87], v[116:119]
    buffer_load_dwordx4 v[244:247], v1, s[24:27], s53 offen offset:2560
    v_mfma_f32_16x16x32_bf16 v[112:115], v[176:179], a[84:87], v[112:115]
    ds_read_b128 a[72:75], v12
    v_fmac_f32 v50, v27, v39
    v_mfma_f32_16x16x32_bf16 v[108:111], v[172:175], a[84:87], v[108:111]
    v_lshl_add_u32 v14, v14, 6, v2
    v_lshl_add_u32 v15, v15, 6, v2
    v_mfma_f32_16x16x32_bf16 v[104:107], v[168:171], a[84:87], v[104:107]
    v_perm_b32 v129, v204, v200, s74
    v_perm_b32 v133, v204, v200, s75
    v_mfma_f32_16x16x32_bf16 v[100:103], v[164:167], a[84:87], v[100:103]
    buffer_load_dwordx4 v[248:251], v1, s[24:27], s53 offen offset:3072
    v_mfma_f32_16x16x32_bf16 v[96:99], v[160:163], a[84:87], v[96:99]
    ds_read_b128 a[76:79], v14
    v_perm_b32 v137, v205, v201, s74
    v_mfma_f32_16x16x32_bf16 a[0:3], v[160:163], a[88:91], a[0:3]
    v_perm_b32 v141, v205, v201, s75
    v_perm_b32 v145, v206, v202, s74
    v_mfma_f32_16x16x32_bf16 a[4:7], v[164:167], a[88:91], a[4:7]
    v_perm_b32 v149, v206, v202, s75
    v_perm_b32 v153, v207, v203, s74
    v_mfma_f32_16x16x32_bf16 a[8:11], v[168:171], a[88:91], a[8:11]
    buffer_load_dwordx4 v[252:255], v1, s[24:27], s53 offen offset:3584
    v_mfma_f32_16x16x32_bf16 a[12:15], v[172:175], a[88:91], a[12:15]
    v_perm_b32 v157, v207, v203, s75
    s_waitcnt lgkmcnt(3)
    v_mad_u32_u24 v42, v42, v44, v45
    v_mfma_f32_16x16x32_bf16 a[16:19], v[176:179], a[88:91], a[16:19]
    v_mad_u32_u24 v43, v43, v44, v45
    s_waitcnt vmcnt(8)
    v_perm_b32 v130, v212, v208, s74
    v_mfma_f32_16x16x32_bf16 a[20:23], v[180:183], a[88:91], a[20:23]
    v_perm_b32 v134, v212, v208, s75
    v_perm_b32 v138, v213, v209, s74
    v_mfma_f32_16x16x32_bf16 a[24:27], v[184:187], a[88:91], a[24:27]
    buffer_load_dwordx4 v[192:195], v1, s[24:27], s54 offen
    v_mfma_f32_16x16x32_bf16 a[28:31], v[188:191], a[88:91], a[28:31]
    ds_read_b128 a[112:115], v42
    v_perm_b32 v142, v213, v209, s75
    v_mfma_f32_16x16x32_bf16 a[60:63], v[188:191], a[92:95], a[60:63]
    v_perm_b32 v146, v214, v210, s74
    v_perm_b32 v150, v214, v210, s75
    v_mfma_f32_16x16x32_bf16 a[56:59], v[184:187], a[92:95], a[56:59]
    ds_read_b128 a[116:119], v42 offset:64512
    v_perm_b32 v154, v215, v211, s74
    v_mfma_f32_16x16x32_bf16 a[52:55], v[180:183], a[92:95], a[52:55]
    buffer_load_dwordx4 v[196:199], v1, s[24:27], s54 offen offset:512
    v_mfma_f32_16x16x32_bf16 a[48:51], v[176:179], a[92:95], a[48:51]
    v_perm_b32 v158, v215, v211, s75
    v_perm_b32 v131, v220, v216, s74
    v_mfma_f32_16x16x32_bf16 a[44:47], v[172:175], a[92:95], a[44:47]
    v_perm_b32 v135, v220, v216, s75
    v_perm_b32 v139, v221, v217, s74
    v_mfma_f32_16x16x32_bf16 a[40:43], v[168:171], a[92:95], a[40:43]
    ds_read_b128 a[120:123], v43
    v_perm_b32 v143, v221, v217, s75
    v_mfma_f32_16x16x32_bf16 a[36:39], v[164:167], a[92:95], a[36:39]
    buffer_load_dwordx4 v[200:203], v1, s[24:27], s54 offen offset:1024
    v_mfma_f32_16x16x32_bf16 a[32:35], v[160:163], a[92:95], a[32:35]
    ds_read_b128 a[124:127], v43 offset:64512
    v_perm_b32 v147, v222, v218, s74
    v_mfma_f32_16x16x32_bf16 v[64:67], v[128:131], a[64:67], v[64:67]
    v_perm_b32 v151, v222, v218, s75
    v_perm_b32 v155, v223, v219, s74
    v_mfma_f32_16x16x32_bf16 v[68:71], v[132:135], a[64:67], v[68:71]
    v_perm_b32 v159, v223, v219, s75
    s_waitcnt vmcnt(7)
    v_perm_b32 v160, v228, v224, s74
    v_mfma_f32_16x16x32_bf16 v[72:75], v[136:139], a[64:67], v[72:75]
    buffer_load_dwordx4 v[204:207], v1, s[24:27], s54 offen offset:1536
    v_mfma_f32_16x16x32_bf16 v[76:79], v[140:143], a[64:67], v[76:79]
    ds_read_b128 a[80:83], v8 offset:64512
    v_perm_b32 v164, v228, v224, s75
    v_mfma_f32_16x16x32_bf16 v[80:83], v[144:147], a[64:67], v[80:83]
    v_perm_b32 v168, v229, v225, s74
    v_perm_b32 v172, v229, v225, s75
    v_mfma_f32_16x16x32_bf16 v[84:87], v[148:151], a[64:67], v[84:87]
    v_perm_b32 v176, v230, v226, s74
    v_perm_b32 v180, v230, v226, s75
    v_mfma_f32_16x16x32_bf16 v[88:91], v[152:155], a[64:67], v[88:91]
    buffer_load_dwordx4 v[208:211], v1, s[24:27], s54 offen offset:2048
    v_mfma_f32_16x16x32_bf16 v[92:95], v[156:159], a[64:67], v[92:95]
    v_perm_b32 v184, v231, v227, s74
    v_perm_b32 v188, v231, v227, s75
    s_waitcnt lgkmcnt(3)
    v_mfma_f32_16x16x32_bf16 v[124:127], v[156:159], a[68:71], v[124:127]
    ds_read_b128 a[84:87], v10 offset:64512
    ds_read2_b32 v[40:41], v46 offset0:104 offset1:117
    v_mfma_f32_16x16x32_bf16 v[120:123], v[152:155], a[68:71], v[120:123]
    v_perm_b32 v161, v236, v232, s74
    v_perm_b32 v165, v236, v232, s75
    v_mfma_f32_16x16x32_bf16 v[116:119], v[148:151], a[68:71], v[116:119]
    buffer_load_dwordx4 v[212:215], v1, s[24:27], s54 offen offset:2560
    v_mfma_f32_16x16x32_bf16 v[112:115], v[144:147], a[68:71], v[112:115]
    ds_read_b128 a[88:91], v12 offset:64512
    v_perm_b32 v169, v237, v233, s74
    v_mfma_f32_16x16x32_bf16 v[108:111], v[140:143], a[68:71], v[108:111]
    v_perm_b32 v173, v237, v233, s75
    v_perm_b32 v177, v238, v234, s74
    v_mfma_f32_16x16x32_bf16 v[104:107], v[136:139], a[68:71], v[104:107]
    ds_read_b128 a[92:95], v14 offset:64512
    v_perm_b32 v181, v238, v234, s75
    v_mfma_f32_16x16x32_bf16 v[100:103], v[132:135], a[68:71], v[100:103]
    buffer_load_dwordx4 v[216:219], v1, s[24:27], s54 offen offset:3072
    v_mfma_f32_16x16x32_bf16 v[96:99], v[128:131], a[68:71], v[96:99]
    v_perm_b32 v185, v239, v235, s74
    v_perm_b32 v189, v239, v235, s75
    v_mfma_f32_16x16x32_bf16 v[28:31], a[112:115], a[112:115], 0
    v_permlane32_swap_b32 v48, v49
    v_mfma_f32_16x16x32_bf16 v[28:31], a[116:119], a[116:119], v[28:31]
    v_add_f32 v48, v48, v49
    s_waitcnt lgkmcnt(4)
    v_mfma_f32_16x16x32_bf16 v[32:35], a[112:115], a[120:123], 0
    buffer_load_dwordx4 v[220:223], v1, s[24:27], s54 offen offset:3584
    v_mfma_f32_16x16x32_bf16 v[32:35], a[116:119], a[124:127], v[32:35]
    s_waitcnt lgkmcnt(2)
    v_mad_u32_u24 v40, v40, v44, v45
    v_mad_u32_u24 v41, v41, v44, v45
    v_mfma_f32_16x16x32_bf16 v[36:39], a[120:123], a[120:123], 0
    s_waitcnt vmcnt(8)
    v_perm_b32 v162, v244, v240, s74
    v_perm_b32 v166, v244, v240, s75
    v_mfma_f32_16x16x32_bf16 v[36:39], a[124:127], a[124:127], v[36:39]
    v_perm_b32 v170, v245, v241, s74
    v_perm_b32 v174, v245, v241, s75
    v_mfma_f32_16x16x32_bf16 a[0:3], v[128:131], a[72:75], a[0:3]
    buffer_load_dwordx4 v[224:227], v1, s[24:27], s55 offen
    v_mfma_f32_16x16x32_bf16 a[4:7], v[132:135], a[72:75], a[4:7]
    v_perm_b32 v178, v246, v242, s74
    v_perm_b32 v182, v246, v242, s75
    v_mfma_f32_16x16x32_bf16 a[8:11], v[136:139], a[72:75], a[8:11]
    v_perm_b32 v186, v247, v243, s74
    v_perm_b32 v190, v247, v243, s75
    v_mfma_f32_16x16x32_bf16 a[12:15], v[140:143], a[72:75], a[12:15]
    ds_read_b128 a[96:99], v40
    v_mul_f32 v51, v16, v28
    v_mfma_f32_16x16x32_bf16 a[16:19], v[144:147], a[72:75], a[16:19]
    buffer_load_dwordx4 v[228:231], v1, s[24:27], s55 offen offset:512
    v_mfma_f32_16x16x32_bf16 a[20:23], v[148:151], a[72:75], a[20:23]
    ds_read_b128 a[100:103], v40 offset:64512
    v_perm_b32 v163, v252, v248, s74
    v_mfma_f32_16x16x32_bf16 a[24:27], v[152:155], a[72:75], a[24:27]
    v_perm_b32 v167, v252, v248, s75
    v_perm_b32 v171, v253, v249, s74
    v_mfma_f32_16x16x32_bf16 a[28:31], v[156:159], a[72:75], a[28:31]
    v_perm_b32 v175, v253, v249, s75
    v_perm_b32 v179, v254, v250, s74
    v_mfma_f32_16x16x32_bf16 a[60:63], v[156:159], a[76:79], a[60:63]
    buffer_load_dwordx4 v[232:235], v1, s[24:27], s55 offen offset:1024
    v_mfma_f32_16x16x32_bf16 a[56:59], v[152:155], a[76:79], a[56:59]
    v_perm_b32 v183, v254, v250, s75
    v_perm_b32 v187, v255, v251, s74
    v_mfma_f32_16x16x32_bf16 a[52:55], v[148:151], a[76:79], a[52:55]
    ds_read_b128 a[104:107], v41
    v_perm_b32 v191, v255, v251, s75
    v_mfma_f32_16x16x32_bf16 a[48:51], v[144:147], a[76:79], a[48:51]
    v_fmac_f32 v51, v17, v29
    v_fmac_f32 v51, v18, v30
    v_mfma_f32_16x16x32_bf16 a[44:47], v[140:143], a[76:79], a[44:47]
    buffer_load_dwordx4 v[236:239], v1, s[24:27], s55 offen offset:1536
    v_mfma_f32_16x16x32_bf16 a[40:43], v[136:139], a[76:79], a[40:43]
    ds_read_b128 a[108:111], v41 offset:64512
    v_fmac_f32 v51, v19, v31
    v_mfma_f32_16x16x32_bf16 a[36:39], v[132:135], a[76:79], a[36:39]
    v_fmac_f32 v51, v20, v32
    v_fmac_f32 v51, v21, v33
    v_mfma_f32_16x16x32_bf16 a[32:35], v[128:131], a[76:79], a[32:35]
    v_fmac_f32 v51, v22, v34
    v_fmac_f32 v51, v23, v35
    v_mfma_f32_16x16x32_bf16 v[64:67], v[160:163], a[80:83], v[64:67]
    buffer_load_dwordx4 v[240:243], v1, s[24:27], s55 offen offset:2048
    v_mfma_f32_16x16x32_bf16 v[68:71], v[164:167], a[80:83], v[68:71]
    v_fmac_f32 v51, v24, v36
    v_fmac_f32 v51, v25, v37
    v_mfma_f32_16x16x32_bf16 v[72:75], v[168:171], a[80:83], v[72:75]
    ds_read_b128 a[64:67], v9
    v_fmac_f32 v51, v26, v38
    v_mfma_f32_16x16x32_bf16 v[76:79], v[172:175], a[80:83], v[76:79]
    v_fmac_f32 v51, v27, v39
    s_waitcnt vmcnt(9)
    v_perm_b32 v128, v196, v192, s74
    v_mfma_f32_16x16x32_bf16 v[80:83], v[176:179], a[80:83], v[80:83]
    buffer_load_dwordx4 v[244:247], v1, s[24:27], s55 offen offset:2560
    v_mfma_f32_16x16x32_bf16 v[84:87], v[180:183], a[80:83], v[84:87]
    v_perm_b32 v132, v196, v192, s75
    v_perm_b32 v136, v197, v193, s74
    v_mfma_f32_16x16x32_bf16 v[88:91], v[184:187], a[80:83], v[88:91]
    v_perm_b32 v140, v197, v193, s75
    v_perm_b32 v144, v198, v194, s74
    v_mfma_f32_16x16x32_bf16 v[92:95], v[188:191], a[80:83], v[92:95]
    v_perm_b32 v148, v198, v194, s75
    v_perm_b32 v152, v199, v195, s74
    v_mfma_f32_16x16x32_bf16 v[124:127], v[188:191], a[84:87], v[124:127]
    buffer_load_dwordx4 v[248:251], v1, s[24:27], s55 offen offset:3072
    v_mfma_f32_16x16x32_bf16 v[120:123], v[184:187], a[84:87], v[120:123]
    ds_read_b128 a[68:71], v11
    v_perm_b32 v156, v199, v195, s75
    v_mfma_f32_16x16x32_bf16 v[116:119], v[180:183], a[84:87], v[116:119]
    v_perm_b32 v129, v204, v200, s74
    v_perm_b32 v133, v204, v200, s75
    v_mfma_f32_16x16x32_bf16 v[112:115], v[176:179], a[84:87], v[112:115]
    ds_read_b128 a[72:75], v13
    v_perm_b32 v137, v205, v201, s74
    v_mfma_f32_16x16x32_bf16 v[108:111], v[172:175], a[84:87], v[108:111]
    buffer_load_dwordx4 v[252:255], v1, s[24:27], s55 offen offset:3584
    v_mfma_f32_16x16x32_bf16 v[104:107], v[168:171], a[84:87], v[104:107]
    ds_read_b128 a[76:79], v15
    v_perm_b32 v141, v205, v201, s75
    v_mfma_f32_16x16x32_bf16 v[100:103], v[164:167], a[84:87], v[100:103]
    v_perm_b32 v145, v206, v202, s74
    v_perm_b32 v149, v206, v202, s75
    v_mfma_f32_16x16x32_bf16 v[96:99], v[160:163], a[84:87], v[96:99]
    v_perm_b32 v153, v207, v203, s74
    v_perm_b32 v157, v207, v203, s75
    s_waitcnt lgkmcnt(4)
    v_mfma_f32_16x16x32_bf16 v[28:31], a[96:99], a[96:99], 0
    buffer_load_dwordx4 v[192:195], v1, s[24:27], s56 offen
    v_mfma_f32_16x16x32_bf16 v[28:31], a[100:103], a[100:103], v[28:31]
    v_permlane32_swap_b32 v50, v51
    v_mfma_f32_16x16x32_bf16 v[32:35], a[96:99], a[104:107], 0
    v_add_f32 v50, v50, v51
    s_waitcnt vmcnt(9)
    v_perm_b32 v130, v212, v208, s74
    v_mfma_f32_16x16x32_bf16 v[32:35], a[100:103], a[108:111], v[32:35]
    v_permlane16_swap_b32 v48, v50
    v_mfma_f32_16x16x32_bf16 v[36:39], a[104:107], a[104:107], 0
    buffer_load_dwordx4 v[196:199], v1, s[24:27], s56 offen offset:512
    v_mfma_f32_16x16x32_bf16 v[36:39], a[108:111], a[108:111], v[36:39]
    v_add_f32 v48, v48, v50
    v_perm_b32 v134, v212, v208, s75
    v_mfma_f32_16x16x32_bf16 a[0:3], v[160:163], a[88:91], a[0:3]
    v_add_f32_dpp v48, v48, v48 row_ror:8 row_mask:0xf bank_mask:0xf
    v_perm_b32 v138, v213, v209, s74
    v_mfma_f32_16x16x32_bf16 a[4:7], v[164:167], a[88:91], a[4:7]
    v_add_f32_dpp v48, v48, v48 row_ror:4 row_mask:0xf bank_mask:0xf
    v_perm_b32 v142, v213, v209, s75
    v_mfma_f32_16x16x32_bf16 a[8:11], v[168:171], a[88:91], a[8:11]
    buffer_load_dwordx4 v[200:203], v1, s[24:27], s56 offen offset:1024
    v_mfma_f32_16x16x32_bf16 a[12:15], v[172:175], a[88:91], a[12:15]
    v_add_f32_dpp v48, v48, v48 row_ror:2 row_mask:0xf bank_mask:0xf
    v_perm_b32 v146, v214, v210, s74
    v_mfma_f32_16x16x32_bf16 a[16:19], v[176:179], a[88:91], a[16:19]
    v_add_f32_dpp v48, v48, v48 row_ror:1 row_mask:0xf bank_mask:0xf
    v_perm_b32 v150, v214, v210, s75
    v_mfma_f32_16x16x32_bf16 a[20:23], v[180:183], a[88:91], a[20:23]
    ds_write_b32 v59, v48
    v_perm_b32 v154, v215, v211, s74
    v_mfma_f32_16x16x32_bf16 a[24:27], v[184:187], a[88:91], a[24:27]
    buffer_load_dwordx4 v[204:207], v1, s[24:27], s56 offen offset:1536
    v_mfma_f32_16x16x32_bf16 a[28:31], v[188:191], a[88:91], a[28:31]
    v_perm_b32 v158, v215, v211, s75
    v_perm_b32 v131, v220, v216, s74
    v_mfma_f32_16x16x32_bf16 a[60:63], v[188:191], a[92:95], a[60:63]
    v_perm_b32 v135, v220, v216, s75
    v_perm_b32 v139, v221, v217, s74
    v_mfma_f32_16x16x32_bf16 a[56:59], v[184:187], a[92:95], a[56:59]
    v_perm_b32 v143, v221, v217, s75
    v_perm_b32 v147, v222, v218, s74
    v_mfma_f32_16x16x32_bf16 a[52:55], v[180:183], a[92:95], a[52:55]
    buffer_load_dwordx4 v[208:211], v1, s[24:27], s56 offen offset:2048
    v_mfma_f32_16x16x32_bf16 a[48:51], v[176:179], a[92:95], a[48:51]
    v_perm_b32 v151, v222, v218, s75
    v_perm_b32 v155, v223, v219, s74
    v_mfma_f32_16x16x32_bf16 a[44:47], v[172:175], a[92:95], a[44:47]
    v_perm_b32 v159, v223, v219, s75
    v_mul_f32 v48, v16, v28
    v_mfma_f32_16x16x32_bf16 a[40:43], v[168:171], a[92:95], a[40:43]
    v_fmac_f32 v48, v17, v29
    v_fmac_f32 v48, v18, v30
    v_mfma_f32_16x16x32_bf16 a[36:39], v[164:167], a[92:95], a[36:39]
    buffer_load_dwordx4 v[212:215], v1, s[24:27], s56 offen offset:2560
    v_mfma_f32_16x16x32_bf16 a[32:35], v[160:163], a[92:95], a[32:35]
    v_fmac_f32 v48, v19, v31
    v_fmac_f32 v48, v20, v32
    s_waitcnt lgkmcnt(1)
    v_mfma_f32_16x16x32_bf16 v[64:67], v[128:131], a[64:67], v[64:67]
    v_fmac_f32 v48, v21, v33
    v_fmac_f32 v48, v22, v34
    v_mfma_f32_16x16x32_bf16 v[68:71], v[132:135], a[64:67], v[68:71]
    v_fmac_f32 v48, v23, v35
    s_waitcnt vmcnt(10)
    v_perm_b32 v160, v228, v224, s74
    v_mfma_f32_16x16x32_bf16 v[72:75], v[136:139], a[64:67], v[72:75]
    buffer_load_dwordx4 v[216:219], v1, s[24:27], s56 offen offset:3072
    v_mfma_f32_16x16x32_bf16 v[76:79], v[140:143], a[64:67], v[76:79]
    v_perm_b32 v164, v228, v224, s75
    v_perm_b32 v168, v229, v225, s74
    v_mfma_f32_16x16x32_bf16 v[80:83], v[144:147], a[64:67], v[80:83]
    v_perm_b32 v172, v229, v225, s75
    v_perm_b32 v176, v230, v226, s74
    v_mfma_f32_16x16x32_bf16 v[84:87], v[148:151], a[64:67], v[84:87]
    ds_read_b128 a[80:83], v9 offset:64512
    ds_read2_b32 v[42:43], v46 offset0:130 offset1:143
    v_mfma_f32_16x16x32_bf16 v[88:91], v[152:155], a[64:67], v[88:91]
    buffer_load_dwordx4 v[220:223], v1, s[24:27], s56 offen offset:3584
    v_mfma_f32_16x16x32_bf16 v[92:95], v[156:159], a[64:67], v[92:95]
    v_perm_b32 v180, v230, v226, s75
    v_perm_b32 v184, v231, v227, s74
    v_mfma_f32_16x16x32_bf16 v[124:127], v[156:159], a[68:71], v[124:127]
    ds_read_b128 a[84:87], v11 offset:64512
    v_perm_b32 v188, v231, v227, s75
    v_mfma_f32_16x16x32_bf16 v[120:123], v[152:155], a[68:71], v[120:123]
    v_fmac_f32 v48, v24, v36
    v_fmac_f32 v48, v25, v37
    v_mfma_f32_16x16x32_bf16 v[116:119], v[148:151], a[68:71], v[116:119]
    buffer_load_dwordx4 v[224:227], v1, s[24:27], s57 offen
    v_mfma_f32_16x16x32_bf16 v[112:115], v[144:147], a[68:71], v[112:115]
    ds_read_b128 a[88:91], v13 offset:64512
    v_fmac_f32 v48, v26, v38
    v_mfma_f32_16x16x32_bf16 v[108:111], v[140:143], a[68:71], v[108:111]
    v_fmac_f32 v48, v27, v39
    v_perm_b32 v161, v236, v232, s74
    v_mfma_f32_16x16x32_bf16 v[104:107], v[136:139], a[68:71], v[104:107]
    v_perm_b32 v165, v236, v232, s75
    v_perm_b32 v169, v237, v233, s74
    v_mfma_f32_16x16x32_bf16 v[100:103], v[132:135], a[68:71], v[100:103]
    buffer_load_dwordx4 v[228:231], v1, s[24:27], s57 offen offset:512
    v_mfma_f32_16x16x32_bf16 v[96:99], v[128:131], a[68:71], v[96:99]
    ds_read_b128 a[92:95], v15 offset:64512
    ds_read2_b32 v[8:9], v3 offset0:4 offset1:5
    v_mfma_f32_16x16x32_bf16 a[0:3], v[128:131], a[72:75], a[0:3]
    ds_read2_b32 v[10:11], v4 offset0:4 offset1:5
    ds_read2_b32 v[12:13], v5 offset0:4 offset1:5
    v_mfma_f32_16x16x32_bf16 a[4:7], v[132:135], a[72:75], a[4:7]
    ds_read2_b32 v[14:15], v6 offset0:4 offset1:5
    v_perm_b32 v173, v237, v233, s75
    v_mfma_f32_16x16x32_bf16 a[8:11], v[136:139], a[72:75], a[8:11]
    v_perm_b32 v177, v238, v234, s74
    v_perm_b32 v181, v238, v234, s75
    v_mfma_f32_16x16x32_bf16 a[12:15], v[140:143], a[72:75], a[12:15]
    v_perm_b32 v185, v239, v235, s74
    v_perm_b32 v189, v239, v235, s75
    v_mfma_f32_16x16x32_bf16 a[16:19], v[144:147], a[72:75], a[16:19]
    buffer_load_dwordx4 v[232:235], v1, s[24:27], s57 offen offset:1024
    v_mfma_f32_16x16x32_bf16 a[20:23], v[148:151], a[72:75], a[20:23]
    s_waitcnt lgkmcnt(7)
    v_mad_u32_u24 v42, v42, v44, v45
    v_mad_u32_u24 v43, v43, v44, v45
    v_mfma_f32_16x16x32_bf16 a[24:27], v[152:155], a[72:75], a[24:27]
    s_waitcnt vmcnt(11)
    v_perm_b32 v162, v244, v240, s74
    v_perm_b32 v166, v244, v240, s75
    v_mfma_f32_16x16x32_bf16 a[28:31], v[156:159], a[72:75], a[28:31]
    ds_read_b128 a[112:115], v42
    v_perm_b32 v170, v245, v241, s74
    v_mfma_f32_16x16x32_bf16 a[60:63], v[156:159], a[76:79], a[60:63]
    buffer_load_dwordx4 v[236:239], v1, s[24:27], s57 offen offset:1536
    v_mfma_f32_16x16x32_bf16 a[56:59], v[152:155], a[76:79], a[56:59]
    ds_read_b128 a[116:119], v42 offset:64512
    v_perm_b32 v174, v245, v241, s75
    v_mfma_f32_16x16x32_bf16 a[52:55], v[148:151], a[76:79], a[52:55]
    v_perm_b32 v178, v246, v242, s74
    v_perm_b32 v182, v246, v242, s75
    v_mfma_f32_16x16x32_bf16 a[48:51], v[144:147], a[76:79], a[48:51]
    v_perm_b32 v186, v247, v243, s74
    v_perm_b32 v190, v247, v243, s75
    v_mfma_f32_16x16x32_bf16 a[44:47], v[140:143], a[76:79], a[44:47]
    buffer_load_dwordx4 v[240:243], v1, s[24:27], s57 offen offset:2048
    v_mfma_f32_16x16x32_bf16 a[40:43], v[136:139], a[76:79], a[40:43]
    ds_read_b128 a[120:123], v43
    v_perm_b32 v163, v252, v248, s74
    v_mfma_f32_16x16x32_bf16 a[36:39], v[132:135], a[76:79], a[36:39]
    v_perm_b32 v167, v252, v248, s75
    v_perm_b32 v171, v253, v249, s74
    v_mfma_f32_16x16x32_bf16 a[32:35], v[128:131], a[76:79], a[32:35]
    ds_read_b128 a[124:127], v43 offset:64512
    v_perm_b32 v175, v253, v249, s75
    v_mfma_f32_16x16x32_bf16 v[64:67], v[160:163], a[80:83], v[64:67]
    buffer_load_dwordx4 v[244:247], v1, s[24:27], s57 offen offset:2560
    v_mfma_f32_16x16x32_bf16 v[68:71], v[164:167], a[80:83], v[68:71]
    v_perm_b32 v179, v254, v250, s74
    v_perm_b32 v183, v254, v250, s75
    v_mfma_f32_16x16x32_bf16 v[72:75], v[168:171], a[80:83], v[72:75]
    v_perm_b32 v187, v255, v251, s74
    v_perm_b32 v191, v255, v251, s75
    v_mfma_f32_16x16x32_bf16 v[76:79], v[172:175], a[80:83], v[76:79]
    s_waitcnt lgkmcnt(4)
    v_lshl_add_u32 v8, v8, 6, v2
    v_lshl_add_u32 v9, v9, 6, v2
    v_mfma_f32_16x16x32_bf16 v[80:83], v[176:179], a[80:83], v[80:83]
    buffer_load_dwordx4 v[248:251], v1, s[24:27], s57 offen offset:3072
    v_mfma_f32_16x16x32_bf16 v[84:87], v[180:183], a[80:83], v[84:87]
    ds_read_b128 a[64:67], v8
    v_lshl_add_u32 v10, v10, 6, v2
    v_mfma_f32_16x16x32_bf16 v[88:91], v[184:187], a[80:83], v[88:91]
    v_lshl_add_u32 v11, v11, 6, v2
    v_lshl_add_u32 v12, v12, 6, v2
    v_mfma_f32_16x16x32_bf16 v[92:95], v[188:191], a[80:83], v[92:95]
    v_lshl_add_u32 v13, v13, 6, v2
    s_waitcnt vmcnt(11)
    v_perm_b32 v128, v196, v192, s74
    v_mfma_f32_16x16x32_bf16 v[124:127], v[188:191], a[84:87], v[124:127]
    buffer_load_dwordx4 v[252:255], v1, s[24:27], s57 offen offset:3584
    v_mfma_f32_16x16x32_bf16 v[120:123], v[184:187], a[84:87], v[120:123]
    ds_read_b128 a[68:71], v10
    v_perm_b32 v132, v196, v192, s75
    v_mfma_f32_16x16x32_bf16 v[116:119], v[180:183], a[84:87], v[116:119]
    v_perm_b32 v136, v197, v193, s74
    v_perm_b32 v140, v197, v193, s75
    v_mfma_f32_16x16x32_bf16 v[112:115], v[176:179], a[84:87], v[112:115]
    ds_read_b128 a[72:75], v12
    ds_read2_b32 v[40:41], v46 offset0:156 offset1:169
    v_mfma_f32_16x16x32_bf16 v[108:111], v[172:175], a[84:87], v[108:111]
    v_perm_b32 v144, v198, v194, s74
    v_perm_b32 v148, v198, v194, s75
    v_mfma_f32_16x16x32_bf16 v[104:107], v[168:171], a[84:87], v[104:107]
    v_perm_b32 v152, v199, v195, s74
    v_perm_b32 v156, v199, v195, s75
    v_mfma_f32_16x16x32_bf16 v[100:103], v[164:167], a[84:87], v[100:103]
    buffer_load_dwordx4 v[192:195], v1, s[24:27], s58 offen
    v_mfma_f32_16x16x32_bf16 v[96:99], v[160:163], a[84:87], v[96:99]
    v_lshl_add_u32 v14, v14, 6, v2
    v_lshl_add_u32 v15, v15, 6, v2
    s_waitcnt lgkmcnt(4)
    v_mfma_f32_16x16x32_bf16 v[28:31], a[112:115], a[112:115], 0
    ds_read_b128 a[76:79], v14
    v_perm_b32 v129, v204, v200, s74
    v_mfma_f32_16x16x32_bf16 v[28:31], a[116:119], a[116:119], v[28:31]
    v_perm_b32 v133, v204, v200, s75
    v_perm_b32 v137, v205, v201, s74
    v_mfma_f32_16x16x32_bf16 v[32:35], a[112:115], a[120:123], 0
    buffer_load_dwordx4 v[196:199], v1, s[24:27], s58 offen offset:512
    v_mfma_f32_16x16x32_bf16 v[32:35], a[116:119], a[124:127], v[32:35]
    v_perm_b32 v141, v205, v201, s75
    v_perm_b32 v145, v206, v202, s74
    v_mfma_f32_16x16x32_bf16 v[36:39], a[120:123], a[120:123], 0
    v_perm_b32 v149, v206, v202, s75
    v_perm_b32 v153, v207, v203, s74
    v_mfma_f32_16x16x32_bf16 v[36:39], a[124:127], a[124:127], v[36:39]
L_hop1:
    s_cbranch_execz L_hop4
    v_perm_b32 v157, v207, v203, s75
    s_waitcnt lgkmcnt(1)
    v_mad_u32_u24 v40, v40, v44, v45
    v_mfma_f32_16x16x32_bf16 a[0:3], v[160:163], a[88:91], a[0:3]
    buffer_load_dwordx4 v[200:203], v1, s[24:27], s58 offen offset:1024
    v_mfma_f32_16x16x32_bf16 a[4:7], v[164:167], a[88:91], a[4:7]
    v_mad_u32_u24 v41, v41, v44, v45
    s_waitcnt vmcnt(11)
    v_perm_b32 v130, v212, v208, s74
    v_mfma_f32_16x16x32_bf16 a[8:11], v[168:171], a[88:91], a[8:11]
    v_perm_b32 v134, v212, v208, s75
    v_perm_b32 v138, v213, v209, s74
    v_mfma_f32_16x16x32_bf16 a[12:15], v[172:175], a[88:91], a[12:15]
    v_perm_b32 v142, v213, v209, s75
    v_perm_b32 v146, v214, v210, s74
    v_mfma_f32_16x16x32_bf16 a[16:19], v[176:179], a[88:91], a[16:19]
    buffer_load_dwordx4 v[204:207], v1, s[24:27], s58 offen offset:1536
    v_mfma_f32_16x16x32_bf16 a[20:23], v[180:183], a[88:91], a[20:23]
    v_perm_b32 v150, v214, v210, s75
    v_perm_b32 v154, v215, v211, s74
    v_mfma_f32_16x16x32_bf16 a[24:27], v[184:187], a[88:91], a[24:27]
    ds_read_b128 a[96:99], v40
    v_perm_b32 v158, v215, v211, s75
    v_mfma_f32_16x16x32_bf16 a[28:31], v[188:191], a[88:91], a[28:31]
    v_perm_b32 v131, v220, v216, s74
    v_perm_b32 v135, v220, v216, s75
    v_mfma_f32_16x16x32_bf16 a[60:63], v[188:191], a[92:95], a[60:63]
    buffer_load_dwordx4 v[208:211], v1, s[24:27], s58 offen offset:2048
    v_mfma_f32_16x16x32_bf16 a[56:59], v[184:187], a[92:95], a[56:59]
    ds_read_b128 a[100:103], v40 offset:64512
    v_perm_b32 v139, v221, v217, s74
    v_mfma_f32_16x16x32_bf16 a[52:55], v[180:183], a[92:95], a[52:55]
    v_perm_b32 v143, v221, v217, s75
    v_perm_b32 v147, v222, v218, s74
    v_mfma_f32_16x16x32_bf16 a[48:51], v[176:179], a[92:95], a[48:51]
    v_perm_b32 v151, v222, v218, s75
    v_perm_b32 v155, v223, v219, s74
    v_mfma_f32_16x16x32_bf16 a[44:47], v[172:175], a[92:95], a[44:47]
    buffer_load_dwordx4 v[212:215], v1, s[24:27], s58 offen offset:2560
    v_mfma_f32_16x16x32_bf16 a[40:43], v[168:171], a[92:95], a[40:43]
    ds_read_b128 a[104:107], v41
    v_perm_b32 v159, v223, v219, s75
    v_mfma_f32_16x16x32_bf16 a[36:39], v[164:167], a[92:95], a[36:39]
    v_mul_f32 v49, v16, v28
    v_fmac_f32 v49, v17, v29
    v_mfma_f32_16x16x32_bf16 a[32:35], v[160:163], a[92:95], a[32:35]
    ds_read_b128 a[108:111], v41 offset:64512
    v_fmac_f32 v49, v18, v30
    v_mfma_f32_16x16x32_bf16 v[64:67], v[128:131], a[64:67], v[64:67]
    buffer_load_dwordx4 v[216:219], v1, s[24:27], s58 offen offset:3072
    v_mfma_f32_16x16x32_bf16 v[68:71], v[132:135], a[64:67], v[68:71]
    v_fmac_f32 v49, v19, v31
    v_fmac_f32 v49, v20, v32
    v_mfma_f32_16x16x32_bf16 v[72:75], v[136:139], a[64:67], v[72:75]
    ds_read_b128 a[80:83], v8 offset:64512
    v_fmac_f32 v49, v21, v33
    v_mfma_f32_16x16x32_bf16 v[76:79], v[140:143], a[64:67], v[76:79]
    v_fmac_f32 v49, v22, v34
    v_fmac_f32 v49, v23, v35
    v_mfma_f32_16x16x32_bf16 v[80:83], v[144:147], a[64:67], v[80:83]
    buffer_load_dwordx4 v[220:223], v1, s[24:27], s58 offen offset:3584
    v_mfma_f32_16x16x32_bf16 v[84:87], v[148:151], a[64:67], v[84:87]
    v_fmac_f32 v49, v24, v36
    v_fmac_f32 v49, v25, v37
    v_mfma_f32_16x16x32_bf16 v[88:91], v[152:155], a[64:67], v[88:91]
    v_fmac_f32 v49, v26, v38
    v_fmac_f32 v49, v27, v39
    v_mfma_f32_16x16x32_bf16 v[92:95], v[156:159], a[64:67], v[92:95]
    s_waitcnt vmcnt(12)
    v_perm_b32 v160, v228, v224, s74
    v_perm_b32 v164, v228, v224, s75
    v_mfma_f32_16x16x32_bf16 v[124:127], v[156:159], a[68:71], v[124:127]
    ds_read_b128 a[84:87], v10 offset:64512
    v_perm_b32 v168, v229, v225, s74
    v_mfma_f32_16x16x32_bf16 v[120:123], v[152:155], a[68:71], v[120:123]
    v_perm_b32 v172, v229, v225, s75
    v_perm_b32 v176, v230, v226, s74
    v_mfma_f32_16x16x32_bf16 v[116:119], v[148:151], a[68:71], v[116:119]
    v_perm_b32 v180, v230, v226, s75
    v_perm_b32 v184, v231, v227, s74
    v_mfma_f32_16x16x32_bf16 v[112:115], v[144:147], a[68:71], v[112:115]
    ds_read_b128 a[88:91], v12 offset:64512
    v_perm_b32 v188, v231, v227, s75
    v_mfma_f32_16x16x32_bf16 v[108:111], v[140:143], a[68:71], v[108:111]
    buffer_load_dwordx4 v[224:227], v1, s[24:27], s59 offen
    v_mfma_f32_16x16x32_bf16 v[104:107], v[136:139], a[68:71], v[104:107]
    ds_read_b128 a[92:95], v14 offset:64512
    v_perm_b32 v161, v236, v232, s74
    v_mfma_f32_16x16x32_bf16 v[100:103], v[132:135], a[68:71], v[100:103]
    v_perm_b32 v165, v236, v232, s75
    v_perm_b32 v169, v237, v233, s74
    v_mfma_f32_16x16x32_bf16 v[96:99], v[128:131], a[68:71], v[96:99]
    v_perm_b32 v173, v237, v233, s75
    v_perm_b32 v177, v238, v234, s74
    s_waitcnt lgkmcnt(4)
    v_mfma_f32_16x16x32_bf16 v[28:31], a[96:99], a[96:99], 0
    buffer_load_dwordx4 v[228:231], v1, s[24:27], s59 offen offset:512
    v_mfma_f32_16x16x32_bf16 v[28:31], a[100:103], a[100:103], v[28:31]
    v_perm_b32 v181, v238, v234, s75
    v_perm_b32 v185, v239, v235, s74
    v_mfma_f32_16x16x32_bf16 v[32:35], a[96:99], a[104:107], 0
    v_perm_b32 v189, v239, v235, s75
    s_waitcnt vmcnt(10)
    v_perm_b32 v162, v244, v240, s74
    v_mfma_f32_16x16x32_bf16 v[32:35], a[100:103], a[108:111], v[32:35]
    v_perm_b32 v166, v244, v240, s75
    v_perm_b32 v170, v245, v241, s74
    v_mfma_f32_16x16x32_bf16 v[36:39], a[104:107], a[104:107], 0
    buffer_load_dwordx4 v[232:235], v1, s[24:27], s59 offen offset:1024
    v_mfma_f32_16x16x32_bf16 v[36:39], a[108:111], a[108:111], v[36:39]
    v_perm_b32 v174, v245, v241, s75
    v_perm_b32 v178, v246, v242, s74
    v_mfma_f32_16x16x32_bf16 a[0:3], v[128:131], a[72:75], a[0:3]
    v_perm_b32 v182, v246, v242, s75
    v_perm_b32 v186, v247, v243, s74
    v_mfma_f32_16x16x32_bf16 a[4:7], v[132:135], a[72:75], a[4:7]
    v_perm_b32 v190, v247, v243, s75
    v_mul_f32 v50, v16, v28
    v_mfma_f32_16x16x32_bf16 a[8:11], v[136:139], a[72:75], a[8:11]
    buffer_load_dwordx4 v[236:239], v1, s[24:27], s59 offen offset:1536
    v_mfma_f32_16x16x32_bf16 a[12:15], v[140:143], a[72:75], a[12:15]
    v_fmac_f32 v50, v17, v29
    v_fmac_f32 v50, v18, v30
    v_mfma_f32_16x16x32_bf16 a[16:19], v[144:147], a[72:75], a[16:19]
    v_fmac_f32 v50, v19, v31
    v_fmac_f32 v50, v20, v32
    v_mfma_f32_16x16x32_bf16 a[20:23], v[148:151], a[72:75], a[20:23]
    v_perm_b32 v163, v252, v248, s74
    v_perm_b32 v167, v252, v248, s75
    v_mfma_f32_16x16x32_bf16 a[24:27], v[152:155], a[72:75], a[24:27]
    buffer_load_dwordx4 v[240:243], v1, s[24:27], s59 offen offset:2048
    v_mfma_f32_16x16x32_bf16 a[28:31], v[156:159], a[72:75], a[28:31]
    v_perm_b32 v171, v253, v249, s74
    v_perm_b32 v175, v253, v249, s75
    v_mfma_f32_16x16x32_bf16 a[60:63], v[156:159], a[76:79], a[60:63]
    v_perm_b32 v179, v254, v250, s74
    v_perm_b32 v183, v254, v250, s75
    v_mfma_f32_16x16x32_bf16 a[56:59], v[152:155], a[76:79], a[56:59]
    v_perm_b32 v187, v255, v251, s74
    v_perm_b32 v191, v255, v251, s75
    v_mfma_f32_16x16x32_bf16 a[52:55], v[148:151], a[76:79], a[52:55]
    buffer_load_dwordx4 v[244:247], v1, s[24:27], s59 offen offset:2560
    v_mfma_f32_16x16x32_bf16 a[48:51], v[144:147], a[76:79], a[48:51]
    v_fmac_f32 v50, v21, v33
    v_fmac_f32 v50, v22, v34
    v_mfma_f32_16x16x32_bf16 a[44:47], v[140:143], a[76:79], a[44:47]
    v_fmac_f32 v50, v23, v35
    v_fmac_f32 v50, v24, v36
    v_mfma_f32_16x16x32_bf16 a[40:43], v[136:139], a[76:79], a[40:43]
    v_fmac_f32 v50, v25, v37
    v_fmac_f32 v50, v26, v38
    v_mfma_f32_16x16x32_bf16 a[36:39], v[132:135], a[76:79], a[36:39]
    buffer_load_dwordx4 v[248:251], v1, s[24:27], s59 offen offset:3072
    v_mfma_f32_16x16x32_bf16 a[32:35], v[128:131], a[76:79], a[32:35]
    s_waitcnt vmcnt(11)
    v_perm_b32 v128, v196, v192, s74
    v_perm_b32 v132, v196, v192, s75
    s_waitcnt lgkmcnt(0)
    v_mfma_f32_16x16x32_bf16 v[64:67], v[160:163], a[80:83], v[64:67]
    v_perm_b32 v136, v197, v193, s74
    v_perm_b32 v140, v197, v193, s75
    v_mfma_f32_16x16x32_bf16 v[68:71], v[164:167], a[80:83], v[68:71]
    v_perm_b32 v144, v198, v194, s74
    v_perm_b32 v148, v198, v194, s75
    v_mfma_f32_16x16x32_bf16 v[72:75], v[168:171], a[80:83], v[72:75]
    buffer_load_dwordx4 v[252:255], v1, s[24:27], s59 offen offset:3584
    v_mfma_f32_16x16x32_bf16 v[76:79], v[172:175], a[80:83], v[76:79]
    v_perm_b32 v152, v199, v195, s74
    v_perm_b32 v156, v199, v195, s75
    v_mfma_f32_16x16x32_bf16 v[80:83], v[176:179], a[80:83], v[80:83]
    ds_read_b128 a[64:67], v9
    v_fmac_f32 v50, v27, v39
    v_mfma_f32_16x16x32_bf16 v[84:87], v[180:183], a[80:83], v[84:87]
    ds_read2_b32 v[42:43], v46 offset0:182 offset1:195
    v_mfma_f32_16x16x32_bf16 v[88:91], v[184:187], a[80:83], v[88:91]
    buffer_load_dwordx4 v[192:195], v1, s[24:27], s60 offen
    v_mfma_f32_16x16x32_bf16 v[92:95], v[188:191], a[80:83], v[92:95]
    ds_read_b128 a[68:71], v11
    v_perm_b32 v129, v204, v200, s74
    v_mfma_f32_16x16x32_bf16 v[124:127], v[188:191], a[84:87], v[124:127]
    v_perm_b32 v133, v204, v200, s75
    v_perm_b32 v137, v205, v201, s74
    v_mfma_f32_16x16x32_bf16 v[120:123], v[184:187], a[84:87], v[120:123]
    ds_read_b128 a[72:75], v13
    v_perm_b32 v141, v205, v201, s75
    v_mfma_f32_16x16x32_bf16 v[116:119], v[180:183], a[84:87], v[116:119]
    buffer_load_dwordx4 v[196:199], v1, s[24:27], s60 offen offset:512
    v_mfma_f32_16x16x32_bf16 v[112:115], v[176:179], a[84:87], v[112:115]
    v_perm_b32 v145, v206, v202, s74
    v_perm_b32 v149, v206, v202, s75
    v_mfma_f32_16x16x32_bf16 v[108:111], v[172:175], a[84:87], v[108:111]
    v_perm_b32 v153, v207, v203, s74
    v_perm_b32 v157, v207, v203, s75
    v_mfma_f32_16x16x32_bf16 v[104:107], v[168:171], a[84:87], v[104:107]
    ds_read_b128 a[76:79], v15
    v_mfma_f32_16x16x32_bf16 v[100:103], v[164:167], a[84:87], v[100:103]
    buffer_load_dwordx4 v[200:203], v1, s[24:27], s60 offen offset:1024
    v_mfma_f32_16x16x32_bf16 v[96:99], v[160:163], a[84:87], v[96:99]
    s_waitcnt lgkmcnt(3)
    v_mad_u32_u24 v42, v42, v44, v45
    v_mad_u32_u24 v43, v43, v44, v45
    v_mfma_f32_16x16x32_bf16 a[0:3], v[160:163], a[88:91], a[0:3]
    s_waitcnt vmcnt(11)
    v_perm_b32 v130, v212, v208, s74
    v_perm_b32 v134, v212, v208, s75
    v_mfma_f32_16x16x32_bf16 a[4:7], v[164:167], a[88:91], a[4:7]
    v_perm_b32 v138, v213, v209, s74
    v_perm_b32 v142, v213, v209, s75
    v_mfma_f32_16x16x32_bf16 a[8:11], v[168:171], a[88:91], a[8:11]
    buffer_load_dwordx4 v[204:207], v1, s[24:27], s60 offen offset:1536
    v_mfma_f32_16x16x32_bf16 a[12:15], v[172:175], a[88:91], a[12:15]
    v_perm_b32 v146, v214, v210, s74
    v_perm_b32 v150, v214, v210, s75
    v_mfma_f32_16x16x32_bf16 a[16:19], v[176:179], a[88:91], a[16:19]
    v_perm_b32 v154, v215, v211, s74
    v_perm_b32 v158, v215, v211, s75
    v_mfma_f32_16x16x32_bf16 a[20:23], v[180:183], a[88:91], a[20:23]
    ds_read_b128 a[112:115], v42
    v_mfma_f32_16x16x32_bf16 a[24:27], v[184:187], a[88:91], a[24:27]
    buffer_load_dwordx4 v[208:211], v1, s[24:27], s60 offen offset:2048
    v_mfma_f32_16x16x32_bf16 a[28:31], v[188:191], a[88:91], a[28:31]
    ds_read_b128 a[116:119], v42 offset:64512
    v_perm_b32 v131, v220, v216, s74
    v_mfma_f32_16x16x32_bf16 a[60:63], v[188:191], a[92:95], a[60:63]
    v_perm_b32 v135, v220, v216, s75
    v_perm_b32 v139, v221, v217, s74
    v_mfma_f32_16x16x32_bf16 a[56:59], v[184:187], a[92:95], a[56:59]
    v_perm_b32 v143, v221, v217, s75
    v_perm_b32 v147, v222, v218, s74
    v_mfma_f32_16x16x32_bf16 a[52:55], v[180:183], a[92:95], a[52:55]
    buffer_load_dwordx4 v[212:215], v1, s[24:27], s60 offen offset:2560
    v_mfma_f32_16x16x32_bf16 a[48:51], v[176:179], a[92:95], a[48:51]
    v_perm_b32 v151, v222, v218, s75
    v_perm_b32 v155, v223, v219, s74
    v_mfma_f32_16x16x32_bf16 a[44:47], v[172:175], a[92:95], a[44:47]
    ds_read_b128 a[120:123], v43
    v_perm_b32 v159, v223, v219, s75
    v_mfma_f32_16x16x32_bf16 a[40:43], v[168:171], a[92:95], a[40:43]
    v_permlane32_swap_b32 v48, v49
    v_mfma_f32_16x16x32_bf16 a[36:39], v[164:167], a[92:95], a[36:39]
    buffer_load_dwordx4 v[216:219], v1, s[24:27], s60 offen offset:3072
    v_mfma_f32_16x16x32_bf16 a[32:35], v[160:163], a[92:95], a[32:35]
    ds_read_b128 a[124:127], v43 offset:64512
    s_waitcnt vmcnt(11)
    v_perm_b32 v160, v228, v224, s74
    v_mfma_f32_16x16x32_bf16 v[64:67], v[128:131], a[64:67], v[64:67]
    v_perm_b32 v164, v228, v224, s75
    v_perm_b32 v168, v229, v225, s74
    v_mfma_f32_16x16x32_bf16 v[68:71], v[132:135], a[64:67], v[68:71]
    v_perm_b32 v172, v229, v225, s75
    v_perm_b32 v176, v230, v226, s74
    v_mfma_f32_16x16x32_bf16 v[72:75], v[136:139], a[64:67], v[72:75]
    buffer_load_dwordx4 v[220:223], v1, s[24:27], s60 offen offset:3584
    v_mfma_f32_16x16x32_bf16 v[76:79], v[140:143], a[64:67], v[76:79]
    ds_read_b128 a[80:83], v9 offset:64512
    v_perm_b32 v180, v230, v226, s75
    v_mfma_f32_16x16x32_bf16 v[80:83], v[144:147], a[64:67], v[80:83]
    v_perm_b32 v184, v231, v227, s74
    v_perm_b32 v188, v231, v227, s75
    v_mfma_f32_16x16x32_bf16 v[84:87], v[148:151], a[64:67], v[84:87]
    ds_read_b128 a[84:87], v11 offset:64512
    ds_read2_b32 v[8:9], v3 offset0:6 offset1:7
    v_mfma_f32_16x16x32_bf16 v[88:91], v[152:155], a[64:67], v[88:91]
    buffer_load_dword v53, v52, s[44:47], 0 offen offset:4 sc1
    v_mfma_f32_16x16x32_bf16 v[92:95], v[156:159], a[64:67], v[92:95]
    ds_read2_b32 v[10:11], v4 offset0:6 offset1:7
    v_add_f32 v48, v48, v49
    s_waitcnt lgkmcnt(6)
    v_mfma_f32_16x16x32_bf16 v[124:127], v[156:159], a[68:71], v[124:127]
    ds_read_b128 a[88:91], v13 offset:64512
    ds_read2_b32 v[40:41], v47 offset0:0 offset1:13
    v_mfma_f32_16x16x32_bf16 v[120:123], v[152:155], a[68:71], v[120:123]
    ds_read2_b32 v[12:13], v5 offset0:6 offset1:7
    v_perm_b32 v161, v236, v232, s74
    v_mfma_f32_16x16x32_bf16 v[116:119], v[148:151], a[68:71], v[116:119]
    buffer_load_dword v7, v54, s[44:47], 0 offen offset:128 sc1
    v_mfma_f32_16x16x32_bf16 v[112:115], v[144:147], a[68:71], v[112:115]
    ds_read_b128 a[92:95], v15 offset:64512
    v_perm_b32 v165, v236, v232, s75
    v_mfma_f32_16x16x32_bf16 v[108:111], v[140:143], a[68:71], v[108:111]
    ds_read2_b32 v[14:15], v6 offset0:6 offset1:7
    v_perm_b32 v169, v237, v233, s74
    v_mfma_f32_16x16x32_bf16 v[104:107], v[136:139], a[68:71], v[104:107]
    v_perm_b32 v173, v237, v233, s75
    v_perm_b32 v177, v238, v234, s74
    v_mfma_f32_16x16x32_bf16 v[100:103], v[132:135], a[68:71], v[100:103]
    buffer_load_dwordx4 v[224:227], v1, s[24:27], s61 offen
    v_mfma_f32_16x16x32_bf16 v[96:99], v[128:131], a[68:71], v[96:99]
    v_perm_b32 v181, v238, v234, s75
    v_perm_b32 v185, v239, v235, s74
    v_mfma_f32_16x16x32_bf16 v[28:31], a[112:115], a[112:115], 0
    v_perm_b32 v189, v239, v235, s75
    s_waitcnt lgkmcnt(6)
    v_lshl_add_u32 v8, v8, 6, v2
    v_mfma_f32_16x16x32_bf16 v[28:31], a[116:119], a[116:119], v[28:31]
    v_lshl_add_u32 v9, v9, 6, v2
    s_waitcnt lgkmcnt(5)
    v_lshl_add_u32 v10, v10, 6, v2
    v_mfma_f32_16x16x32_bf16 v[32:35], a[112:115], a[120:123], 0
    buffer_load_dwordx4 v[228:231], v1, s[24:27], s61 offen offset:512
    v_mfma_f32_16x16x32_bf16 v[32:35], a[116:119], a[124:127], v[32:35]
    s_waitcnt lgkmcnt(3)
    v_mad_u32_u24 v40, v40, v44, v45
    v_mad_u32_u24 v41, v41, v44, v45
    v_mfma_f32_16x16x32_bf16 v[36:39], a[120:123], a[120:123], 0
    s_waitcnt vmcnt(12)
    v_perm_b32 v162, v244, v240, s74
    v_perm_b32 v166, v244, v240, s75
    v_mfma_f32_16x16x32_bf16 v[36:39], a[124:127], a[124:127], v[36:39]
    v_perm_b32 v170, v245, v241, s74
    v_perm_b32 v174, v245, v241, s75
    v_mfma_f32_16x16x32_bf16 a[0:3], v[128:131], a[72:75], a[0:3]
    buffer_load_dwordx4 v[232:235], v1, s[24:27], s61 offen offset:1024
    v_mfma_f32_16x16x32_bf16 a[4:7], v[132:135], a[72:75], a[4:7]
    v_perm_b32 v178, v246, v242, s74
    v_perm_b32 v182, v246, v242, s75
    v_mfma_f32_16x16x32_bf16 a[8:11], v[136:139], a[72:75], a[8:11]
    v_perm_b32 v186, v247, v243, s74
    v_perm_b32 v190, v247, v243, s75
    v_mfma_f32_16x16x32_bf16 a[12:15], v[140:143], a[72:75], a[12:15]
    ds_read_b128 a[96:99], v40
    v_mul_f32 v51, v16, v28
    v_mfma_f32_16x16x32_bf16 a[16:19], v[144:147], a[72:75], a[16:19]
    buffer_load_dwordx4 v[236:239], v1, s[24:27], s61 offen offset:1536
    v_mfma_f32_16x16x32_bf16 a[20:23], v[148:151], a[72:75], a[20:23]
    ds_read_b128 a[100:103], v40 offset:64512
    v_perm_b32 v163, v252, v248, s74
    v_mfma_f32_16x16x32_bf16 a[24:27], v[152:155], a[72:75], a[24:27]
    v_perm_b32 v167, v252, v248, s75
    v_perm_b32 v171, v253, v249, s74
    v_mfma_f32_16x16x32_bf16 a[28:31], v[156:159], a[72:75], a[28:31]
    v_perm_b32 v175, v253, v249, s75
    v_perm_b32 v179, v254, v250, s74
    v_mfma_f32_16x16x32_bf16 a[60:63], v[156:159], a[76:79], a[60:63]
    buffer_load_dwordx4 v[240:243], v1, s[24:27], s61 offen offset:2048
    v_mfma_f32_16x16x32_bf16 a[56:59], v[152:155], a[76:79], a[56:59]
    v_perm_b32 v183, v254, v250, s75
    v_perm_b32 v187, v255, v251, s74
    v_mfma_f32_16x16x32_bf16 a[52:55], v[148:151], a[76:79], a[52:55]
    ds_read_b128 a[104:107], v41
    v_perm_b32 v191, v255, v251, s75
    v_mfma_f32_16x16x32_bf16 a[48:51], v[144:147], a[76:79], a[48:51]
    v_fmac_f32 v51, v17, v29
    v_fmac_f32 v51, v18, v30
    v_mfma_f32_16x16x32_bf16 a[44:47], v[140:143], a[76:79], a[44:47]
    buffer_load_dwordx4 v[244:247], v1, s[24:27], s61 offen offset:2560
    v_mfma_f32_16x16x32_bf16 a[40:43], v[136:139], a[76:79], a[40:43]
    ds_read_b128 a[108:111], v41 offset:64512
    v_fmac_f32 v51, v19, v31
    v_mfma_f32_16x16x32_bf16 a[36:39], v[132:135], a[76:79], a[36:39]
    v_lshl_add_u32 v11, v11, 6, v2
    v_fmac_f32 v51, v20, v32
    v_mfma_f32_16x16x32_bf16 a[32:35], v[128:131], a[76:79], a[32:35]
    v_fmac_f32 v51, v21, v33
    v_fmac_f32 v51, v22, v34
    v_mfma_f32_16x16x32_bf16 v[64:67], v[160:163], a[80:83], v[64:67]
    buffer_load_dwordx4 v[248:251], v1, s[24:27], s61 offen offset:3072
    v_mfma_f32_16x16x32_bf16 v[68:71], v[164:167], a[80:83], v[68:71]
    v_fmac_f32 v51, v23, v35
    s_waitcnt lgkmcnt(3)
    v_lshl_add_u32 v12, v12, 6, v2
    v_mfma_f32_16x16x32_bf16 v[72:75], v[168:171], a[80:83], v[72:75]
    ds_read_b128 a[64:67], v8
    v_lshl_add_u32 v13, v13, 6, v2
    v_mfma_f32_16x16x32_bf16 v[76:79], v[172:175], a[80:83], v[76:79]
    v_fmac_f32 v51, v24, v36
    v_fmac_f32 v51, v25, v37
    v_mfma_f32_16x16x32_bf16 v[80:83], v[176:179], a[80:83], v[80:83]
    buffer_load_dwordx4 v[252:255], v1, s[24:27], s61 offen offset:3584
    v_mfma_f32_16x16x32_bf16 v[84:87], v[180:183], a[80:83], v[84:87]
    v_fmac_f32 v51, v26, v38
    v_fmac_f32 v51, v27, v39
    v_mfma_f32_16x16x32_bf16 v[88:91], v[184:187], a[80:83], v[88:91]
    s_waitcnt vmcnt(14)
    v_perm_b32 v128, v196, v192, s74
    v_perm_b32 v132, v196, v192, s75
    v_mfma_f32_16x16x32_bf16 v[92:95], v[188:191], a[80:83], v[92:95]
    v_perm_b32 v136, v197, v193, s74
    v_perm_b32 v140, v197, v193, s75
    v_mfma_f32_16x16x32_bf16 v[124:127], v[188:191], a[84:87], v[124:127]
    ds_read_b128 a[68:71], v10
    v_perm_b32 v144, v198, v194, s74
    v_mfma_f32_16x16x32_bf16 v[120:123], v[184:187], a[84:87], v[120:123]
    v_perm_b32 v148, v198, v194, s75
    v_perm_b32 v152, v199, v195, s74
    v_mfma_f32_16x16x32_bf16 v[116:119], v[180:183], a[84:87], v[116:119]
    v_perm_b32 v156, v199, v195, s75
    v_lshl_add_u32 v14, v14, 6, v2
    v_mfma_f32_16x16x32_bf16 v[112:115], v[176:179], a[84:87], v[112:115]
    buffer_load_dwordx4 v[192:195], v1, s[24:27], s62 offen
    v_mfma_f32_16x16x32_bf16 v[108:111], v[172:175], a[84:87], v[108:111]
    ds_read_b128 a[72:75], v12
    v_lshl_add_u32 v15, v15, 6, v2
    v_mfma_f32_16x16x32_bf16 v[104:107], v[168:171], a[84:87], v[104:107]
    v_perm_b32 v129, v204, v200, s74
    v_perm_b32 v133, v204, v200, s75
    v_mfma_f32_16x16x32_bf16 v[100:103], v[164:167], a[84:87], v[100:103]
    ds_read_b128 a[76:79], v14
    v_perm_b32 v137, v205, v201, s74
    v_mfma_f32_16x16x32_bf16 v[96:99], v[160:163], a[84:87], v[96:99]
    buffer_load_dwordx4 v[196:199], v1, s[24:27], s62 offen offset:512
    v_mfma_f32_16x16x32_bf16 v[28:31], a[96:99], a[96:99], 0
    v_perm_b32 v141, v205, v201, s75
    v_perm_b32 v145, v206, v202, s74
    s_waitcnt lgkmcnt(3)
    v_mfma_f32_16x16x32_bf16 v[28:31], a[100:103], a[100:103], v[28:31]
    v_perm_b32 v149, v206, v202, s75
    v_perm_b32 v153, v207, v203, s74
    v_mfma_f32_16x16x32_bf16 v[32:35], a[96:99], a[104:107], 0
    v_perm_b32 v157, v207, v203, s75
    s_waitcnt vmcnt(12)
    v_perm_b32 v130, v212, v208, s74
    v_mfma_f32_16x16x32_bf16 v[32:35], a[100:103], a[108:111], v[32:35]
    buffer_load_dwordx4 v[200:203], v1, s[24:27], s62 offen offset:1024
    v_mfma_f32_16x16x32_bf16 v[36:39], a[104:107], a[104:107], 0
    v_permlane32_swap_b32 v50, v51
    v_mfma_f32_16x16x32_bf16 v[36:39], a[108:111], a[108:111], v[36:39]
    v_add_f32 v50, v50, v51
    v_perm_b32 v134, v212, v208, s75
    v_mfma_f32_16x16x32_bf16 a[0:3], v[160:163], a[88:91], a[0:3]
    v_permlane16_swap_b32 v48, v50
    v_mfma_f32_16x16x32_bf16 a[4:7], v[164:167], a[88:91], a[4:7]
    buffer_load_dwordx4 v[204:207], v1, s[24:27], s62 offen offset:1536
    v_mfma_f32_16x16x32_bf16 a[8:11], v[168:171], a[88:91], a[8:11]
    v_add_f32 v48, v48, v50
    v_perm_b32 v138, v213, v209, s74
    v_mfma_f32_16x16x32_bf16 a[12:15], v[172:175], a[88:91], a[12:15]
    v_add_f32_dpp v48, v48, v48 row_ror:8 row_mask:0xf bank_mask:0xf
    v_perm_b32 v142, v213, v209, s75
    v_mfma_f32_16x16x32_bf16 a[16:19], v[176:179], a[88:91], a[16:19]
    v_add_f32_dpp v48, v48, v48 row_ror:4 row_mask:0xf bank_mask:0xf
    v_perm_b32 v146, v214, v210, s74
    v_mfma_f32_16x16x32_bf16 a[20:23], v[180:183], a[88:91], a[20:23]
    v_add_f32_dpp v48, v48, v48 row_ror:2 row_mask:0xf bank_mask:0xf
    v_perm_b32 v150, v214, v210, s75
    v_mfma_f32_16x16x32_bf16 a[24:27], v[184:187], a[88:91], a[24:27]
    v_add_f32_dpp v48, v48, v48 row_ror:1 row_mask:0xf bank_mask:0xf
    v_perm_b32 v154, v215, v211, s74
    v_mfma_f32_16x16x32_bf16 a[28:31], v[188:191], a[88:91], a[28:31]
    ds_write_b32 v59, v48 offset:16
    v_perm_b32 v158, v215, v211, s75
    v_mfma_f32_16x16x32_bf16 a[60:63], v[188:191], a[92:95], a[60:63]
    buffer_load_dwordx4 v[208:211], v1, s[24:27], s62 offen offset:2048
    v_mfma_f32_16x16x32_bf16 a[56:59], v[184:187], a[92:95], a[56:59]
    v_perm_b32 v131, v220, v216, s74
    v_perm_b32 v135, v220, v216, s75
    v_mfma_f32_16x16x32_bf16 a[52:55], v[180:183], a[92:95], a[52:55]
    v_perm_b32 v139, v221, v217, s74
    v_perm_b32 v143, v221, v217, s75
    v_mfma_f32_16x16x32_bf16 a[48:51], v[176:179], a[92:95], a[48:51]
    v_perm_b32 v147, v222, v218, s74
    v_perm_b32 v151, v222, v218, s75
    v_mfma_f32_16x16x32_bf16 a[44:47], v[172:175], a[92:95], a[44:47]
    buffer_load_dwordx4 v[212:215], v1, s[24:27], s62 offen offset:2560
    v_mfma_f32_16x16x32_bf16 a[40:43], v[168:171], a[92:95], a[40:43]
    v_perm_b32 v155, v223, v219, s74
    v_perm_b32 v159, v223, v219, s75
    v_mfma_f32_16x16x32_bf16 a[36:39], v[164:167], a[92:95], a[36:39]
    v_mul_f32 v48, v16, v28
    v_fmac_f32 v48, v17, v29
    v_mfma_f32_16x16x32_bf16 a[32:35], v[160:163], a[92:95], a[32:35]
    v_fmac_f32 v48, v18, v30
    v_fmac_f32 v48, v19, v31
    v_mfma_f32_16x16x32_bf16 v[64:67], v[128:131], a[64:67], v[64:67]
    buffer_load_dwordx4 v[216:219], v1, s[24:27], s62 offen offset:3072
    v_mfma_f32_16x16x32_bf16 v[68:71], v[132:135], a[64:67], v[68:71]
    v_fmac_f32 v48, v20, v32
    v_fmac_f32 v48, v21, v33
    v_mfma_f32_16x16x32_bf16 v[72:75], v[136:139], a[64:67], v[72:75]
    v_fmac_f32 v48, v22, v34
    v_fmac_f32 v48, v23, v35
    v_mfma_f32_16x16x32_bf16 v[76:79], v[140:143], a[64:67], v[76:79]
    s_waitcnt vmcnt(11)
    v_perm_b32 v160, v228, v224, s74
    v_perm_b32 v164, v228, v224, s75
    v_mfma_f32_16x16x32_bf16 v[80:83], v[144:147], a[64:67], v[80:83]
    buffer_load_dwordx4 v[220:223], v1, s[24:27], s62 offen offset:3584
    v_mfma_f32_16x16x32_bf16 v[84:87], v[148:151], a[64:67], v[84:87]
    ds_read_b128 a[80:83], v8 offset:64512
    ds_read2_b32 v[42:43], v47 offset0:26 offset1:39
    v_mfma_f32_16x16x32_bf16 v[88:91], v[152:155], a[64:67], v[88:91]
    v_perm_b32 v168, v229, v225, s74
    v_perm_b32 v172, v229, v225, s75
    v_mfma_f32_16x16x32_bf16 v[92:95], v[156:159], a[64:67], v[92:95]
    v_perm_b32 v176, v230, v226, s74
    v_perm_b32 v180, v230, v226, s75
    s_waitcnt lgkmcnt(2)
    v_mfma_f32_16x16x32_bf16 v[124:127], v[156:159], a[68:71], v[124:127]
    ds_read_b128 a[84:87], v10 offset:64512
    v_perm_b32 v184, v231, v227, s74
    v_mfma_f32_16x16x32_bf16 v[120:123], v[152:155], a[68:71], v[120:123]
    v_perm_b32 v188, v231, v227, s75
    v_fmac_f32 v48, v24, v36
    v_mfma_f32_16x16x32_bf16 v[116:119], v[148:151], a[68:71], v[116:119]
    buffer_load_dwordx4 v[224:227], v1, s[24:27], s63 offen
    v_mfma_f32_16x16x32_bf16 v[112:115], v[144:147], a[68:71], v[112:115]
    ds_read_b128 a[88:91], v12 offset:64512
    v_fmac_f32 v48, v25, v37
    v_mfma_f32_16x16x32_bf16 v[108:111], v[140:143], a[68:71], v[108:111]
    v_fmac_f32 v48, v26, v38
    v_fmac_f32 v48, v27, v39
    v_mfma_f32_16x16x32_bf16 v[104:107], v[136:139], a[68:71], v[104:107]
    v_perm_b32 v161, v236, v232, s74
    v_perm_b32 v165, v236, v232, s75
    v_mfma_f32_16x16x32_bf16 v[100:103], v[132:135], a[68:71], v[100:103]
    buffer_load_dwordx4 v[228:231], v1, s[24:27], s63 offen offset:512
    v_mfma_f32_16x16x32_bf16 v[96:99], v[128:131], a[68:71], v[96:99]
    ds_read_b128 a[92:95], v14 offset:64512
    v_perm_b32 v169, v237, v233, s74
    v_mfma_f32_16x16x32_bf16 a[0:3], v[128:131], a[72:75], a[0:3]
    v_perm_b32 v173, v237, v233, s75
    v_perm_b32 v177, v238, v234, s74
    v_mfma_f32_16x16x32_bf16 a[4:7], v[132:135], a[72:75], a[4:7]
    v_perm_b32 v181, v238, v234, s75
    v_perm_b32 v185, v239, v235, s74
    v_mfma_f32_16x16x32_bf16 a[8:11], v[136:139], a[72:75], a[8:11]
    v_perm_b32 v189, v239, v235, s75
    s_waitcnt lgkmcnt(3)
    v_mad_u32_u24 v42, v42, v44, v45
    v_mfma_f32_16x16x32_bf16 a[12:15], v[140:143], a[72:75], a[12:15]
    buffer_load_dwordx4 v[232:235], v1, s[24:27], s63 offen offset:1024
    v_mfma_f32_16x16x32_bf16 a[16:19], v[144:147], a[72:75], a[16:19]
    v_mad_u32_u24 v43, v43, v44, v45
    s_waitcnt vmcnt(11)
    v_perm_b32 v162, v244, v240, s74
    v_mfma_f32_16x16x32_bf16 a[20:23], v[148:151], a[72:75], a[20:23]
    v_perm_b32 v166, v244, v240, s75
    v_perm_b32 v170, v245, v241, s74
    v_mfma_f32_16x16x32_bf16 a[24:27], v[152:155], a[72:75], a[24:27]
    v_perm_b32 v174, v245, v241, s75
    v_perm_b32 v178, v246, v242, s74
    v_mfma_f32_16x16x32_bf16 a[28:31], v[156:159], a[72:75], a[28:31]
    buffer_load_dwordx4 v[236:239], v1, s[24:27], s63 offen offset:1536
    v_mfma_f32_16x16x32_bf16 a[60:63], v[156:159], a[76:79], a[60:63]
    ds_read_b128 a[112:115], v42
    v_perm_b32 v182, v246, v242, s75
    v_mfma_f32_16x16x32_bf16 a[56:59], v[152:155], a[76:79], a[56:59]
    v_perm_b32 v186, v247, v243, s74
    v_perm_b32 v190, v247, v243, s75
    v_mfma_f32_16x16x32_bf16 a[52:55], v[148:151], a[76:79], a[52:55]
    ds_read_b128 a[116:119], v42 offset:64512
    v_perm_b32 v163, v252, v248, s74
    v_mfma_f32_16x16x32_bf16 a[48:51], v[144:147], a[76:79], a[48:51]
    buffer_load_dwordx4 v[240:243], v1, s[24:27], s63 offen offset:2048
    v_mfma_f32_16x16x32_bf16 a[44:47], v[140:143], a[76:79], a[44:47]
    v_perm_b32 v167, v252, v248, s75
    v_perm_b32 v171, v253, v249, s74
    v_mfma_f32_16x16x32_bf16 a[40:43], v[136:139], a[76:79], a[40:43]
L_hop2:
    s_cbranch_execz L_hopback
    ds_read_b128 a[120:123], v43
    v_perm_b32 v175, v253, v249, s75
    v_mfma_f32_16x16x32_bf16 a[36:39], v[132:135], a[76:79], a[36:39]
    v_perm_b32 v179, v254, v250, s74
    v_perm_b32 v183, v254, v250, s75
    v_mfma_f32_16x16x32_bf16 a[32:35], v[128:131], a[76:79], a[32:35]
    buffer_load_dwordx4 v[244:247], v1, s[24:27], s63 offen offset:2560
    v_mfma_f32_16x16x32_bf16 v[64:67], v[160:163], a[80:83], v[64:67]
    ds_read_b128 a[124:127], v43 offset:64512
    v_perm_b32 v187, v255, v251, s74
    v_mfma_f32_16x16x32_bf16 v[68:71], v[164:167], a[80:83], v[68:71]
    v_perm_b32 v191, v255, v251, s75
    v_sub_u32 v7, v7, v53
    v_mfma_f32_16x16x32_bf16 v[72:75], v[168:171], a[80:83], v[72:75]
    ds_read_b128 a[64:67], v9
    v_cmp_ne_u32 vcc, 0x5bd1e995, v7
    v_mfma_f32_16x16x32_bf16 v[76:79], v[172:175], a[80:83], v[76:79]
    buffer_load_dwordx4 v[248:251], v1, s[24:27], s63 offen offset:3072
    v_mfma_f32_16x16x32_bf16 v[80:83], v[176:179], a[80:83], v[80:83]
    v_add_u32 v7, 0x5bd1e995, v53
    s_and_b32 s3, vcc_lo, 0xffff
    s_waitcnt vmcnt(11)
    v_perm_b32 v128, v196, v192, s74
    v_mfma_f32_16x16x32_bf16 v[84:87], v[180:183], a[80:83], v[84:87]
    v_perm_b32 v132, v196, v192, s75
    v_perm_b32 v136, v197, v193, s74
    v_mfma_f32_16x16x32_bf16 v[88:91], v[184:187], a[80:83], v[88:91]
    v_perm_b32 v140, v197, v193, s75
    v_perm_b32 v144, v198, v194, s74
    v_mfma_f32_16x16x32_bf16 v[92:95], v[188:191], a[80:83], v[92:95]
    buffer_load_dwordx4 v[252:255], v1, s[24:27], s63 offen offset:3584
    s_waitcnt lgkmcnt(4)
    v_mfma_f32_16x16x32_bf16 v[124:127], v[188:191], a[84:87], v[124:127]
    buffer_store_dword v7, v55, s[44:47], 0 offen offset:128 sc1
    ds_read_b128 a[68:71], v11
    v_mfma_f32_16x16x32_bf16 v[120:123], v[184:187], a[84:87], v[120:123]
    v_perm_b32 v148, v198, v194, s75
    v_perm_b32 v152, v199, v195, s74
    v_mfma_f32_16x16x32_bf16 v[116:119], v[180:183], a[84:87], v[116:119]
    ds_read_b128 a[72:75], v13
    v_perm_b32 v156, v199, v195, s75
    v_mfma_f32_16x16x32_bf16 v[112:115], v[176:179], a[84:87], v[112:115]
    buffer_load_dwordx4 v[192:195], v1, s[24:27], s64 offen
    v_mfma_f32_16x16x32_bf16 v[108:111], v[172:175], a[84:87], v[108:111]
    ds_read2_b32 v[40:41], v47 offset0:52 offset1:65
    ds_read_b128 a[76:79], v15
    v_mfma_f32_16x16x32_bf16 v[104:107], v[168:171], a[84:87], v[104:107]
    v_perm_b32 v129, v204, v200, s74
    v_perm_b32 v133, v204, v200, s75
    v_mfma_f32_16x16x32_bf16 v[100:103], v[164:167], a[84:87], v[100:103]
    v_perm_b32 v137, v205, v201, s74
    v_perm_b32 v141, v205, v201, s75
    v_mfma_f32_16x16x32_bf16 v[96:99], v[160:163], a[84:87], v[96:99]
    buffer_load_dwordx4 v[196:199], v1, s[24:27], s64 offen offset:512
    v_mfma_f32_16x16x32_bf16 v[28:31], a[112:115], a[112:115], 0
    v_perm_b32 v145, v206, v202, s74
    v_perm_b32 v149, v206, v202, s75
    s_waitcnt lgkmcnt(4)
    v_mfma_f32_16x16x32_bf16 v[28:31], a[116:119], a[116:119], v[28:31]
    v_perm_b32 v153, v207, v203, s74
    v_perm_b32 v157, v207, v203, s75
    v_mfma_f32_16x16x32_bf16 v[32:35], a[112:115], a[120:123], 0
    s_waitcnt vmcnt(11)
    v_perm_b32 v130, v212, v208, s74
    v_perm_b32 v134, v212, v208, s75
    v_mfma_f32_16x16x32_bf16 v[32:35], a[116:119], a[124:127], v[32:35]
    buffer_load_dwordx4 v[200:203], v1, s[24:27], s64 offen offset:1024
    v_mfma_f32_16x16x32_bf16 v[36:39], a[120:123], a[120:123], 0
    v_perm_b32 v138, v213, v209, s74
    v_perm_b32 v142, v213, v209, s75
    v_mfma_f32_16x16x32_bf16 v[36:39], a[124:127], a[124:127], v[36:39]
    v_perm_b32 v146, v214, v210, s74
    v_perm_b32 v150, v214, v210, s75
    v_mfma_f32_16x16x32_bf16 a[0:3], v[160:163], a[88:91], a[0:3]
    s_waitcnt lgkmcnt(1)
    v_mad_u32_u24 v40, v40, v44, v45
    v_mad_u32_u24 v41, v41, v44, v45
    v_mfma_f32_16x16x32_bf16 a[4:7], v[164:167], a[88:91], a[4:7]
    buffer_load_dwordx4 v[204:207], v1, s[24:27], s64 offen offset:1536
    v_mfma_f32_16x16x32_bf16 a[8:11], v[168:171], a[88:91], a[8:11]
    v_perm_b32 v154, v215, v211, s74
    v_perm_b32 v158, v215, v211, s75
    v_mfma_f32_16x16x32_bf16 a[12:15], v[172:175], a[88:91], a[12:15]
    ds_read_b128 a[96:99], v40
    v_mul_f32 v49, v16, v28
    v_mfma_f32_16x16x32_bf16 a[16:19], v[176:179], a[88:91], a[16:19]
    v_fmac_f32 v49, v17, v29
    v_fmac_f32 v49, v18, v30
    v_mfma_f32_16x16x32_bf16 a[20:23], v[180:183], a[88:91], a[20:23]
    buffer_load_dwordx4 v[208:211], v1, s[24:27], s64 offen offset:2048
    v_mfma_f32_16x16x32_bf16 a[24:27], v[184:187], a[88:91], a[24:27]
    ds_read_b128 a[100:103], v40 offset:64512
    v_perm_b32 v131, v220, v216, s74
    v_mfma_f32_16x16x32_bf16 a[28:31], v[188:191], a[88:91], a[28:31]
    v_perm_b32 v135, v220, v216, s75
    v_perm_b32 v139, v221, v217, s74
    v_mfma_f32_16x16x32_bf16 a[60:63], v[188:191], a[92:95], a[60:63]
    v_perm_b32 v143, v221, v217, s75
    v_perm_b32 v147, v222, v218, s74
    v_mfma_f32_16x16x32_bf16 a[56:59], v[184:187], a[92:95], a[56:59]
    buffer_load_dwordx4 v[212:215], v1, s[24:27], s64 offen offset:2560
    v_mfma_f32_16x16x32_bf16 a[52:55], v[180:183], a[92:95], a[52:55]
    v_perm_b32 v151, v222, v218, s75
    v_perm_b32 v155, v223, v219, s74
    v_mfma_f32_16x16x32_bf16 a[48:51], v[176:179], a[92:95], a[48:51]
    ds_read_b128 a[104:107], v41
    v_perm_b32 v159, v223, v219, s75
    v_mfma_f32_16x16x32_bf16 a[44:47], v[172:175], a[92:95], a[44:47]
    v_fmac_f32 v49, v19, v31
    v_fmac_f32 v49, v20, v32
    v_mfma_f32_16x16x32_bf16 a[40:43], v[168:171], a[92:95], a[40:43]
    buffer_load_dwordx4 v[216:219], v1, s[24:27], s64 offen offset:3072
    v_mfma_f32_16x16x32_bf16 a[36:39], v[164:167], a[92:95], a[36:39]
    ds_read_b128 a[108:111], v41 offset:64512
    v_fmac_f32 v49, v21, v33
    v_mfma_f32_16x16x32_bf16 a[32:35], v[160:163], a[92:95], a[32:35]
    v_fmac_f32 v49, v22, v34
    v_fmac_f32 v49, v23, v35
    v_mfma_f32_16x16x32_bf16 v[64:67], v[128:131], a[64:67], v[64:67]
    v_fmac_f32 v49, v24, v36
    v_fmac_f32 v49, v25, v37
    v_mfma_f32_16x16x32_bf16 v[68:71], v[132:135], a[64:67], v[68:71]
    buffer_load_dwordx4 v[220:223], v1, s[24:27], s64 offen offset:3584
    v_mfma_f32_16x16x32_bf16 v[72:75], v[136:139], a[64:67], v[72:75]
    ds_read_b128 a[80:83], v9 offset:64512
    v_fmac_f32 v49, v26, v38
    v_mfma_f32_16x16x32_bf16 v[76:79], v[140:143], a[64:67], v[76:79]
    v_fmac_f32 v49, v27, v39
    s_waitcnt vmcnt(13)
    v_perm_b32 v160, v228, v224, s74
    v_mfma_f32_16x16x32_bf16 v[80:83], v[144:147], a[64:67], v[80:83]
    v_perm_b32 v164, v228, v224, s75
    v_perm_b32 v168, v229, v225, s74
    v_mfma_f32_16x16x32_bf16 v[84:87], v[148:151], a[64:67], v[84:87]
    v_perm_b32 v172, v229, v225, s75
    v_perm_b32 v176, v230, v226, s74
    v_mfma_f32_16x16x32_bf16 v[88:91], v[152:155], a[64:67], v[88:91]
    v_perm_b32 v180, v230, v226, s75
    v_perm_b32 v184, v231, v227, s74
    v_mfma_f32_16x16x32_bf16 v[92:95], v[156:159], a[64:67], v[92:95]
    ds_read_b128 a[84:87], v11 offset:64512
    v_perm_b32 v188, v231, v227, s75
    v_mfma_f32_16x16x32_bf16 v[124:127], v[156:159], a[68:71], v[124:127]
    buffer_load_dwordx4 v[224:227], v1, s[24:27], s65 offen
    v_mfma_f32_16x16x32_bf16 v[120:123], v[152:155], a[68:71], v[120:123]
    ds_read_b128 a[88:91], v13 offset:64512
    ds_read2_b32 v[8:9], v3 offset0:8 offset1:9
    v_mfma_f32_16x16x32_bf16 v[116:119], v[148:151], a[68:71], v[116:119]
    ds_read2_b32 v[10:11], v4 offset0:8 offset1:9
    ds_read2_b32 v[12:13], v5 offset0:8 offset1:9
    v_mfma_f32_16x16x32_bf16 v[112:115], v[144:147], a[68:71], v[112:115]
    ds_read_b128 a[92:95], v15 offset:64512
    v_perm_b32 v161, v236, v232, s74
    v_mfma_f32_16x16x32_bf16 v[108:111], v[140:143], a[68:71], v[108:111]
    buffer_load_dwordx4 v[228:231], v1, s[24:27], s65 offen offset:512
    v_mfma_f32_16x16x32_bf16 v[104:107], v[136:139], a[68:71], v[104:107]
    ds_read2_b32 v[14:15], v6 offset0:8 offset1:9
    v_perm_b32 v165, v236, v232, s75
    v_mfma_f32_16x16x32_bf16 v[100:103], v[132:135], a[68:71], v[100:103]
    v_perm_b32 v169, v237, v233, s74
    v_perm_b32 v173, v237, v233, s75
    v_mfma_f32_16x16x32_bf16 v[96:99], v[128:131], a[68:71], v[96:99]
    v_perm_b32 v177, v238, v234, s74
    v_perm_b32 v181, v238, v234, s75
    s_waitcnt lgkmcnt(8)
    v_mfma_f32_16x16x32_bf16 v[28:31], a[96:99], a[96:99], 0
    v_perm_b32 v185, v239, v235, s74
    v_perm_b32 v189, v239, v235, s75
    v_mfma_f32_16x16x32_bf16 v[28:31], a[100:103], a[100:103], v[28:31]
    buffer_load_dwordx4 v[232:235], v1, s[24:27], s65 offen offset:1024
    v_mfma_f32_16x16x32_bf16 v[32:35], a[96:99], a[104:107], 0
    s_waitcnt vmcnt(12)
    v_perm_b32 v162, v244, v240, s74
    v_perm_b32 v166, v244, v240, s75
    v_mfma_f32_16x16x32_bf16 v[32:35], a[100:103], a[108:111], v[32:35]
    v_perm_b32 v170, v245, v241, s74
    v_perm_b32 v174, v245, v241, s75
    v_mfma_f32_16x16x32_bf16 v[36:39], a[104:107], a[104:107], 0
    v_perm_b32 v178, v246, v242, s74
    v_perm_b32 v182, v246, v242, s75
    v_mfma_f32_16x16x32_bf16 v[36:39], a[108:111], a[108:111], v[36:39]
    buffer_load_dwordx4 v[236:239], v1, s[24:27], s65 offen offset:1536
    v_mfma_f32_16x16x32_bf16 a[0:3], v[128:131], a[72:75], a[0:3]
    v_perm_b32 v186, v247, v243, s74
    v_perm_b32 v190, v247, v243, s75
    v_mfma_f32_16x16x32_bf16 a[4:7], v[132:135], a[72:75], a[4:7]
    s_waitcnt lgkmcnt(4)
    v_lshl_add_u32 v8, v8, 6, v2
    v_lshl_add_u32 v9, v9, 6, v2
    v_mfma_f32_16x16x32_bf16 a[8:11], v[136:139], a[72:75], a[8:11]
    v_mul_f32 v50, v16, v28
    v_fmac_f32 v50, v17, v29
    v_mfma_f32_16x16x32_bf16 a[12:15], v[140:143], a[72:75], a[12:15]
    buffer_load_dwordx4 v[240:243], v1, s[24:27], s65 offen offset:2048
    v_mfma_f32_16x16x32_bf16 a[16:19], v[144:147], a[72:75], a[16:19]
    v_fmac_f32 v50, v18, v30
    v_fmac_f32 v50, v19, v31
    v_mfma_f32_16x16x32_bf16 a[20:23], v[148:151], a[72:75], a[20:23]
    v_perm_b32 v163, v252, v248, s74
    v_perm_b32 v167, v252, v248, s75
    v_mfma_f32_16x16x32_bf16 a[24:27], v[152:155], a[72:75], a[24:27]
    v_perm_b32 v171, v253, v249, s74
    v_perm_b32 v175, v253, v249, s75
    v_mfma_f32_16x16x32_bf16 a[28:31], v[156:159], a[72:75], a[28:31]
    buffer_load_dwordx4 v[244:247], v1, s[24:27], s65 offen offset:2560
    v_mfma_f32_16x16x32_bf16 a[60:63], v[156:159], a[76:79], a[60:63]
    v_perm_b32 v179, v254, v250, s74
    v_perm_b32 v183, v254, v250, s75
    v_mfma_f32_16x16x32_bf16 a[56:59], v[152:155], a[76:79], a[56:59]
    v_perm_b32 v187, v255, v251, s74
    v_perm_b32 v191, v255, v251, s75
    v_mfma_f32_16x16x32_bf16 a[52:55], v[148:151], a[76:79], a[52:55]
    s_waitcnt lgkmcnt(0)
    v_lshl_add_u32 v10, v10, 6, v2
    v_lshl_add_u32 v11, v11, 6, v2
    v_mfma_f32_16x16x32_bf16 a[48:51], v[144:147], a[76:79], a[48:51]
    buffer_load_dwordx4 v[248:251], v1, s[24:27], s65 offen offset:3072
    v_mfma_f32_16x16x32_bf16 a[44:47], v[140:143], a[76:79], a[44:47]
    v_fmac_f32 v50, v20, v32
    v_fmac_f32 v50, v21, v33
    v_mfma_f32_16x16x32_bf16 a[40:43], v[136:139], a[76:79], a[40:43]
    v_fmac_f32 v50, v22, v34
    v_fmac_f32 v50, v23, v35
    v_mfma_f32_16x16x32_bf16 a[36:39], v[132:135], a[76:79], a[36:39]
    v_lshl_add_u32 v12, v12, 6, v2
    v_lshl_add_u32 v13, v13, 6, v2
    v_mfma_f32_16x16x32_bf16 a[32:35], v[128:131], a[76:79], a[32:35]
    buffer_load_dwordx4 v[252:255], v1, s[24:27], s65 offen offset:3584
    v_mfma_f32_16x16x32_bf16 v[64:67], v[160:163], a[80:83], v[64:67]
    s_waitcnt vmcnt(12)
    v_perm_b32 v128, v196, v192, s74
    v_perm_b32 v132, v196, v192, s75
    v_mfma_f32_16x16x32_bf16 v[68:71], v[164:167], a[80:83], v[68:71]
    v_perm_b32 v136, v197, v193, s74
    v_perm_b32 v140, v197, v193, s75
    v_mfma_f32_16x16x32_bf16 v[72:75], v[168:171], a[80:83], v[72:75]
    v_perm_b32 v144, v198, v194, s74
    v_perm_b32 v148, v198, v194, s75
    v_mfma_f32_16x16x32_bf16 v[76:79], v[172:175], a[80:83], v[76:79]
    v_perm_b32 v152, v199, v195, s74
    v_perm_b32 v156, v199, v195, s75
    v_mfma_f32_16x16x32_bf16 v[80:83], v[176:179], a[80:83], v[80:83]
    ds_read_b128 a[64:67], v8
    v_fmac_f32 v50, v24, v36
    v_mfma_f32_16x16x32_bf16 v[84:87], v[180:183], a[80:83], v[84:87]
    ds_read2_b32 v[42:43], v47 offset0:78 offset1:91
    v_fmac_f32 v50, v25, v37
    v_mfma_f32_16x16x32_bf16 v[88:91], v[184:187], a[80:83], v[88:91]
    buffer_load_dwordx4 v[192:195], v1, s[24:27], s66 offen
    v_mfma_f32_16x16x32_bf16 v[92:95], v[188:191], a[80:83], v[92:95]
    v_fmac_f32 v50, v26, v38
    v_fmac_f32 v50, v27, v39
    v_mfma_f32_16x16x32_bf16 v[124:127], v[188:191], a[84:87], v[124:127]
    ds_read_b128 a[68:71], v10
    v_lshl_add_u32 v14, v14, 6, v2
    v_mfma_f32_16x16x32_bf16 v[120:123], v[184:187], a[84:87], v[120:123]
    v_lshl_add_u32 v15, v15, 6, v2
    v_perm_b32 v129, v204, v200, s74
    v_mfma_f32_16x16x32_bf16 v[116:119], v[180:183], a[84:87], v[116:119]
    buffer_load_dwordx4 v[196:199], v1, s[24:27], s66 offen offset:512
    v_mfma_f32_16x16x32_bf16 v[112:115], v[176:179], a[84:87], v[112:115]
    ds_read_b128 a[72:75], v12
    v_perm_b32 v133, v204, v200, s75
    v_mfma_f32_16x16x32_bf16 v[108:111], v[172:175], a[84:87], v[108:111]
    v_perm_b32 v137, v205, v201, s74
    v_perm_b32 v141, v205, v201, s75
    v_mfma_f32_16x16x32_bf16 v[104:107], v[168:171], a[84:87], v[104:107]
    v_perm_b32 v145, v206, v202, s74
    v_perm_b32 v149, v206, v202, s75
    v_mfma_f32_16x16x32_bf16 v[100:103], v[164:167], a[84:87], v[100:103]
    ds_read_b128 a[76:79], v14
    v_perm_b32 v153, v207, v203, s74
    v_mfma_f32_16x16x32_bf16 v[96:99], v[160:163], a[84:87], v[96:99]
    v_perm_b32 v157, v207, v203, s75
    s_waitcnt lgkmcnt(3)
    v_mad_u32_u24 v42, v42, v44, v45
    v_mfma_f32_16x16x32_bf16 a[0:3], v[160:163], a[88:91], a[0:3]
    buffer_load_dwordx4 v[200:203], v1, s[24:27], s66 offen offset:1024
    v_mfma_f32_16x16x32_bf16 a[4:7], v[164:167], a[88:91], a[4:7]
    v_mad_u32_u24 v43, v43, v44, v45
    s_waitcnt vmcnt(11)
    v_perm_b32 v130, v212, v208, s74
    v_mfma_f32_16x16x32_bf16 a[8:11], v[168:171], a[88:91], a[8:11]
    v_perm_b32 v134, v212, v208, s75
    v_perm_b32 v138, v213, v209, s74
    v_mfma_f32_16x16x32_bf16 a[12:15], v[172:175], a[88:91], a[12:15]
    v_perm_b32 v142, v213, v209, s75
    v_perm_b32 v146, v214, v210, s74
    v_mfma_f32_16x16x32_bf16 a[16:19], v[176:179], a[88:91], a[16:19]
    buffer_load_dwordx4 v[204:207], v1, s[24:27], s66 offen offset:1536
    v_mfma_f32_16x16x32_bf16 a[20:23], v[180:183], a[88:91], a[20:23]
    v_perm_b32 v150, v214, v210, s75
    v_perm_b32 v154, v215, v211, s74
    v_mfma_f32_16x16x32_bf16 a[24:27], v[184:187], a[88:91], a[24:27]
    ds_read_b128 a[112:115], v42
    v_perm_b32 v158, v215, v211, s75
    v_mfma_f32_16x16x32_bf16 a[28:31], v[188:191], a[88:91], a[28:31]
    v_perm_b32 v131, v220, v216, s74
    v_perm_b32 v135, v220, v216, s75
    v_mfma_f32_16x16x32_bf16 a[60:63], v[188:191], a[92:95], a[60:63]
    buffer_load_dwordx4 v[208:211], v1, s[24:27], s66 offen offset:2048
    v_mfma_f32_16x16x32_bf16 a[56:59], v[184:187], a[92:95], a[56:59]
    ds_read_b128 a[116:119], v42 offset:64512
    v_perm_b32 v139, v221, v217, s74
    v_mfma_f32_16x16x32_bf16 a[52:55], v[180:183], a[92:95], a[52:55]
    v_perm_b32 v143, v221, v217, s75
    v_perm_b32 v147, v222, v218, s74
    v_mfma_f32_16x16x32_bf16 a[48:51], v[176:179], a[92:95], a[48:51]
    v_perm_b32 v151, v222, v218, s75
    v_perm_b32 v155, v223, v219, s74
    v_mfma_f32_16x16x32_bf16 a[44:47], v[172:175], a[92:95], a[44:47]
    buffer_load_dwordx4 v[212:215], v1, s[24:27], s66 offen offset:2560
    v_mfma_f32_16x16x32_bf16 a[40:43], v[168:171], a[92:95], a[40:43]
    ds_read_b128 a[120:123], v43
    v_perm_b32 v159, v223, v219, s75
    v_mfma_f32_16x16x32_bf16 a[36:39], v[164:167], a[92:95], a[36:39]
    v_permlane32_swap_b32 v48, v49
    v_mfma_f32_16x16x32_bf16 a[32:35], v[160:163], a[92:95], a[32:35]
    ds_read_b128 a[124:127], v43 offset:64512
    s_waitcnt vmcnt(10)
    v_perm_b32 v160, v228, v224, s74
    v_mfma_f32_16x16x32_bf16 v[64:67], v[128:131], a[64:67], v[64:67]
    buffer_load_dwordx4 v[216:219], v1, s[24:27], s66 offen offset:3072
    v_mfma_f32_16x16x32_bf16 v[68:71], v[132:135], a[64:67], v[68:71]
    v_perm_b32 v164, v228, v224, s75
    v_perm_b32 v168, v229, v225, s74
    v_mfma_f32_16x16x32_bf16 v[72:75], v[136:139], a[64:67], v[72:75]
    ds_read_b128 a[80:83], v8 offset:64512
    v_perm_b32 v172, v229, v225, s75
    v_mfma_f32_16x16x32_bf16 v[76:79], v[140:143], a[64:67], v[76:79]
    v_perm_b32 v176, v230, v226, s74
    v_perm_b32 v180, v230, v226, s75
    v_mfma_f32_16x16x32_bf16 v[80:83], v[144:147], a[64:67], v[80:83]
    buffer_load_dwordx4 v[220:223], v1, s[24:27], s66 offen offset:3584
    v_mfma_f32_16x16x32_bf16 v[84:87], v[148:151], a[64:67], v[84:87]
    v_perm_b32 v184, v231, v227, s74
    v_perm_b32 v188, v231, v227, s75
    v_mfma_f32_16x16x32_bf16 v[88:91], v[152:155], a[64:67], v[88:91]
    ds_read_b128 a[84:87], v10 offset:64512
    v_add_f32 v48, v48, v49
    v_mfma_f32_16x16x32_bf16 v[92:95], v[156:159], a[64:67], v[92:95]
    s_waitcnt lgkmcnt(4)
    v_mfma_f32_16x16x32_bf16 v[124:127], v[156:159], a[68:71], v[124:127]
    buffer_load_dwordx4 v[224:227], v1, s[24:27], s67 offen
    v_mfma_f32_16x16x32_bf16 v[120:123], v[152:155], a[68:71], v[120:123]
    ds_read_b128 a[88:91], v12 offset:64512
    ds_read2_b32 v[40:41], v47 offset0:104 offset1:117
    v_mfma_f32_16x16x32_bf16 v[116:119], v[148:151], a[68:71], v[116:119]
    v_perm_b32 v161, v236, v232, s74
    v_perm_b32 v165, v236, v232, s75
    v_mfma_f32_16x16x32_bf16 v[112:115], v[144:147], a[68:71], v[112:115]
    ds_read_b128 a[92:95], v14 offset:64512
    v_perm_b32 v169, v237, v233, s74
    v_mfma_f32_16x16x32_bf16 v[108:111], v[140:143], a[68:71], v[108:111]
    buffer_load_dwordx4 v[228:231], v1, s[24:27], s67 offen offset:512
    v_mfma_f32_16x16x32_bf16 v[104:107], v[136:139], a[68:71], v[104:107]
    v_perm_b32 v173, v237, v233, s75
    v_perm_b32 v177, v238, v234, s74
    v_mfma_f32_16x16x32_bf16 v[100:103], v[132:135], a[68:71], v[100:103]
    v_perm_b32 v181, v238, v234, s75
    v_perm_b32 v185, v239, v235, s74
    v_mfma_f32_16x16x32_bf16 v[96:99], v[128:131], a[68:71], v[96:99]
    v_perm_b32 v189, v239, v235, s75
    v_mfma_f32_16x16x32_bf16 v[28:31], a[112:115], a[112:115], 0
    buffer_load_dwordx4 v[232:235], v1, s[24:27], s67 offen offset:1024
    v_mfma_f32_16x16x32_bf16 v[28:31], a[116:119], a[116:119], v[28:31]
    s_waitcnt lgkmcnt(4)
    v_mfma_f32_16x16x32_bf16 v[32:35], a[112:115], a[120:123], 0
    s_waitcnt vmcnt(11)
    v_perm_b32 v162, v244, v240, s74
    v_perm_b32 v166, v244, v240, s75
    v_mfma_f32_16x16x32_bf16 v[32:35], a[116:119], a[124:127], v[32:35]
    s_waitcnt lgkmcnt(1)
    v_mad_u32_u24 v40, v40, v44, v45
    v_mad_u32_u24 v41, v41, v44, v45
    v_mfma_f32_16x16x32_bf16 v[36:39], a[120:123], a[120:123], 0
    buffer_load_dwordx4 v[236:239], v1, s[24:27], s67 offen offset:1536
    v_mfma_f32_16x16x32_bf16 v[36:39], a[124:127], a[124:127], v[36:39]
    v_perm_b32 v170, v245, v241, s74
    v_perm_b32 v174, v245, v241, s75
    v_mfma_f32_16x16x32_bf16 a[0:3], v[128:131], a[72:75], a[0:3]
    v_perm_b32 v178, v246, v242, s74
    v_perm_b32 v182, v246, v242, s75
    v_mfma_f32_16x16x32_bf16 a[4:7], v[132:135], a[72:75], a[4:7]
    v_perm_b32 v186, v247, v243, s74
    v_perm_b32 v190, v247, v243, s75
    v_mfma_f32_16x16x32_bf16 a[8:11], v[136:139], a[72:75], a[8:11]
    buffer_load_dwordx4 v[240:243], v1, s[24:27], s67 offen offset:2048
    v_mfma_f32_16x16x32_bf16 a[12:15], v[140:143], a[72:75], a[12:15]
    ds_read_b128 a[96:99], v40
    v_mul_f32 v51, v16, v28
    v_mfma_f32_16x16x32_bf16 a[16:19], v[144:147], a[72:75], a[16:19]
    v_fmac_f32 v51, v17, v29
    v_fmac_f32 v51, v18, v30
    v_mfma_f32_16x16x32_bf16 a[20:23], v[148:151], a[72:75], a[20:23]
    ds_read_b128 a[100:103], v40 offset:64512
    v_perm_b32 v163, v252, v248, s74
    v_mfma_f32_16x16x32_bf16 a[24:27], v[152:155], a[72:75], a[24:27]
    buffer_load_dwordx4 v[244:247], v1, s[24:27], s67 offen offset:2560
    v_mfma_f32_16x16x32_bf16 a[28:31], v[156:159], a[72:75], a[28:31]
    v_perm_b32 v167, v252, v248, s75
    v_perm_b32 v171, v253, v249, s74
    v_mfma_f32_16x16x32_bf16 a[60:63], v[156:159], a[76:79], a[60:63]
    v_perm_b32 v175, v253, v249, s75
    v_perm_b32 v179, v254, v250, s74
    v_mfma_f32_16x16x32_bf16 a[56:59], v[152:155], a[76:79], a[56:59]
    v_perm_b32 v183, v254, v250, s75
    v_perm_b32 v187, v255, v251, s74
    v_mfma_f32_16x16x32_bf16 a[52:55], v[148:151], a[76:79], a[52:55]
    ds_read_b128 a[104:107], v41
    v_perm_b32 v191, v255, v251, s75
    v_mfma_f32_16x16x32_bf16 a[48:51], v[144:147], a[76:79], a[48:51]
    buffer_load_dwordx4 v[248:251], v1, s[24:27], s67 offen offset:3072
    v_mfma_f32_16x16x32_bf16 a[44:47], v[140:143], a[76:79], a[44:47]
    ds_read_b128 a[108:111], v41 offset:64512
    v_fmac_f32 v51, v19, v31
    v_mfma_f32_16x16x32_bf16 a[40:43], v[136:139], a[76:79], a[40:43]
    v_fmac_f32 v51, v20, v32
    v_fmac_f32 v51, v21, v33
    v_mfma_f32_16x16x32_bf16 a[36:39], v[132:135], a[76:79], a[36:39]
    v_fmac_f32 v51, v22, v34
    v_fmac_f32 v51, v23, v35
    v_mfma_f32_16x16x32_bf16 a[32:35], v[128:131], a[76:79], a[32:35]
    buffer_load_dwordx4 v[252:255], v1, s[24:27], s67 offen offset:3584
    v_mfma_f32_16x16x32_bf16 v[64:67], v[160:163], a[80:83], v[64:67]
    v_fmac_f32 v51, v24, v36
    v_fmac_f32 v51, v25, v37
    v_mfma_f32_16x16x32_bf16 v[68:71], v[164:167], a[80:83], v[68:71]
    v_fmac_f32 v51, v26, v38
    v_fmac_f32 v51, v27, v39
    v_mfma_f32_16x16x32_bf16 v[72:75], v[168:171], a[80:83], v[72:75]
    ds_read_b128 a[64:67], v9
    s_waitcnt vmcnt(12)
    v_perm_b32 v128, v196, v192, s74
    v_mfma_f32_16x16x32_bf16 v[76:79], v[172:175], a[80:83], v[76:79]
    v_perm_b32 v132, v196, v192, s75
    v_perm_b32 v136, v197, v193, s74
    v_mfma_f32_16x16x32_bf16 v[80:83], v[176:179], a[80:83], v[80:83]
    v_perm_b32 v140, v197, v193, s75
    v_perm_b32 v144, v198, v194, s74
    v_mfma_f32_16x16x32_bf16 v[84:87], v[180:183], a[80:83], v[84:87]
    v_perm_b32 v148, v198, v194, s75
    v_perm_b32 v152, v199, v195, s74
    v_mfma_f32_16x16x32_bf16 v[88:91], v[184:187], a[80:83], v[88:91]
    ds_read_b128 a[68:71], v11
    v_perm_b32 v156, v199, v195, s75
    v_mfma_f32_16x16x32_bf16 v[92:95], v[188:191], a[80:83], v[92:95]
    buffer_load_dwordx4 v[192:195], v1, s[24:27], s68 offen
    v_mfma_f32_16x16x32_bf16 v[124:127], v[188:191], a[84:87], v[124:127]
    ds_read_b128 a[72:75], v13
    v_perm_b32 v129, v204, v200, s74
    v_mfma_f32_16x16x32_bf16 v[120:123], v[184:187], a[84:87], v[120:123]
    v_perm_b32 v133, v204, v200, s75
    v_perm_b32 v137, v205, v201, s74
    v_mfma_f32_16x16x32_bf16 v[116:119], v[180:183], a[84:87], v[116:119]
    v_perm_b32 v141, v205, v201, s75
    v_perm_b32 v145, v206, v202, s74
    v_mfma_f32_16x16x32_bf16 v[112:115], v[176:179], a[84:87], v[112:115]
    buffer_load_dwordx4 v[196:199], v1, s[24:27], s68 offen offset:512
    v_mfma_f32_16x16x32_bf16 v[108:111], v[172:175], a[84:87], v[108:111]
    ds_read_b128 a[76:79], v15
    v_perm_b32 v149, v206, v202, s75
    v_mfma_f32_16x16x32_bf16 v[104:107], v[168:171], a[84:87], v[104:107]
    v_perm_b32 v153, v207, v203, s74
    v_perm_b32 v157, v207, v203, s75
    v_mfma_f32_16x16x32_bf16 v[100:103], v[164:167], a[84:87], v[100:103]
    v_permlane32_swap_b32 v50, v51
    v_mfma_f32_16x16x32_bf16 v[96:99], v[160:163], a[84:87], v[96:99]
    buffer_load_dwordx4 v[200:203], v1, s[24:27], s68 offen offset:1024
    s_waitcnt lgkmcnt(4)
    v_mfma_f32_16x16x32_bf16 v[28:31], a[96:99], a[96:99], 0
    v_add_f32 v50, v50, v51
    v_mfma_f32_16x16x32_bf16 v[28:31], a[100:103], a[100:103], v[28:31]
    v_mfma_f32_16x16x32_bf16 v[32:35], a[96:99], a[104:107], 0
    v_permlane16_swap_b32 v48, v50
    v_mfma_f32_16x16x32_bf16 v[32:35], a[100:103], a[108:111], v[32:35]
    buffer_load_dwordx4 v[204:207], v1, s[24:27], s68 offen offset:1536
    v_mfma_f32_16x16x32_bf16 v[36:39], a[104:107], a[104:107], 0
    v_add_f32 v48, v48, v50
    s_waitcnt vmcnt(12)
    v_perm_b32 v130, v212, v208, s74
    v_mfma_f32_16x16x32_bf16 v[36:39], a[108:111], a[108:111], v[36:39]
    v_add_f32_dpp v48, v48, v48 row_ror:8 row_mask:0xf bank_mask:0xf
    v_perm_b32 v134, v212, v208, s75
    v_mfma_f32_16x16x32_bf16 a[0:3], v[160:163], a[88:91], a[0:3]
    v_add_f32_dpp v48, v48, v48 row_ror:4 row_mask:0xf bank_mask:0xf
    v_perm_b32 v138, v213, v209, s74
    v_mfma_f32_16x16x32_bf16 a[4:7], v[164:167], a[88:91], a[4:7]
    v_add_f32_dpp v48, v48, v48 row_ror:2 row_mask:0xf bank_mask:0xf
    v_perm_b32 v142, v213, v209, s75
    v_mfma_f32_16x16x32_bf16 a[8:11], v[168:171], a[88:91], a[8:11]
    v_add_f32_dpp v48, v48, v48 row_ror:1 row_mask:0xf bank_mask:0xf
    v_perm_b32 v146, v214, v210, s74
    v_mfma_f32_16x16x32_bf16 a[12:15], v[172:175], a[88:91], a[12:15]
    ds_write_b32 v59, v48 offset:32
    v_perm_b32 v150, v214, v210, s75
    v_mfma_f32_16x16x32_bf16 a[16:19], v[176:179], a[88:91], a[16:19]
    v_perm_b32 v154, v215, v211, s74
    v_perm_b32 v158, v215, v211, s75
    v_mfma_f32_16x16x32_bf16 a[20:23], v[180:183], a[88:91], a[20:23]
    buffer_load_dwordx4 v[208:211], v1, s[24:27], s68 offen offset:2048
    v_mfma_f32_16x16x32_bf16 a[24:27], v[184:187], a[88:91], a[24:27]
    v_perm_b32 v131, v220, v216, s74
    v_perm_b32 v135, v220, v216, s75
    v_mfma_f32_16x16x32_bf16 a[28:31], v[188:191], a[88:91], a[28:31]
    v_perm_b32 v139, v221, v217, s74
    v_perm_b32 v143, v221, v217, s75
    v_mfma_f32_16x16x32_bf16 a[60:63], v[188:191], a[92:95], a[60:63]
    v_perm_b32 v147, v222, v218, s74
    v_perm_b32 v151, v222, v218, s75
    v_mfma_f32_16x16x32_bf16 a[56:59], v[184:187], a[92:95], a[56:59]
    buffer_load_dwordx4 v[212:215], v1, s[24:27], s68 offen offset:2560
    v_mfma_f32_16x16x32_bf16 a[52:55], v[180:183], a[92:95], a[52:55]
    v_perm_b32 v155, v223, v219, s74
    v_perm_b32 v159, v223, v219, s75
    v_mfma_f32_16x16x32_bf16 a[48:51], v[176:179], a[92:95], a[48:51]
    v_mul_f32 v48, v16, v28
    v_fmac_f32 v48, v17, v29
    v_mfma_f32_16x16x32_bf16 a[44:47], v[172:175], a[92:95], a[44:47]
    v_fmac_f32 v48, v18, v30
    v_fmac_f32 v48, v19, v31
    v_mfma_f32_16x16x32_bf16 a[40:43], v[168:171], a[92:95], a[40:43]
    buffer_load_dwordx4 v[216:219], v1, s[24:27], s68 offen offset:3072
    v_mfma_f32_16x16x32_bf16 a[36:39], v[164:167], a[92:95], a[36:39]
    v_fmac_f32 v48, v20, v32
    v_fmac_f32 v48, v21, v33
    v_mfma_f32_16x16x32_bf16 a[32:35], v[160:163], a[92:95], a[32:35]
    v_fmac_f32 v48, v22, v34
    v_fmac_f32 v48, v23, v35
    s_waitcnt lgkmcnt(1)
    v_mfma_f32_16x16x32_bf16 v[64:67], v[128:131], a[64:67], v[64:67]
    s_waitcnt vmcnt(11)
    v_perm_b32 v160, v228, v224, s74
    v_perm_b32 v164, v228, v224, s75
    v_mfma_f32_16x16x32_bf16 v[68:71], v[132:135], a[64:67], v[68:71]
    buffer_load_dwordx4 v[220:223], v1, s[24:27], s68 offen offset:3584
    v_mfma_f32_16x16x32_bf16 v[72:75], v[136:139], a[64:67], v[72:75]
    v_perm_b32 v168, v229, v225, s74
    v_perm_b32 v172, v229, v225, s75
    v_mfma_f32_16x16x32_bf16 v[76:79], v[140:143], a[64:67], v[76:79]
    v_perm_b32 v176, v230, v226, s74
    v_perm_b32 v180, v230, v226, s75
    v_mfma_f32_16x16x32_bf16 v[80:83], v[144:147], a[64:67], v[80:83]
    v_perm_b32 v184, v231, v227, s74
    v_perm_b32 v188, v231, v227, s75
    v_mfma_f32_16x16x32_bf16 v[84:87], v[148:151], a[64:67], v[84:87]
    ds_read_b128 a[80:83], v9 offset:64512
    ds_read2_b32 v[42:43], v47 offset0:130 offset1:143
    v_mfma_f32_16x16x32_bf16 v[88:91], v[152:155], a[64:67], v[88:91]
L_hop3:
    s_cbranch_execz L_hopback
    buffer_load_dwordx4 v[224:227], v1, s[24:27], s69 offen
    v_mfma_f32_16x16x32_bf16 v[92:95], v[156:159], a[64:67], v[92:95]
    ds_read_b128 a[84:87], v11 offset:64512
    v_fmac_f32 v48, v24, v36
    v_mfma_f32_16x16x32_bf16 v[124:127], v[156:159], a[68:71], v[124:127]
    v_fmac_f32 v48, v25, v37
    v_fmac_f32 v48, v26, v38
    v_mfma_f32_16x16x32_bf16 v[120:123], v[152:155], a[68:71], v[120:123]
    ds_read_b128 a[88:91], v13 offset:64512
    v_fmac_f32 v48, v27, v39
    v_mfma_f32_16x16x32_bf16 v[116:119], v[148:151], a[68:71], v[116:119]
    buffer_load_dwordx4 v[228:231], v1, s[24:27], s69 offen offset:512
    v_mfma_f32_16x16x32_bf16 v[112:115], v[144:147], a[68:71], v[112:115]
    v_perm_b32 v161, v236, v232, s74
    v_perm_b32 v165, v236, v232, s75
    v_mfma_f32_16x16x32_bf16 v[108:111], v[140:143], a[68:71], v[108:111]
    v_perm_b32 v169, v237, v233, s74
    v_perm_b32 v173, v237, v233, s75
    v_mfma_f32_16x16x32_bf16 v[104:107], v[136:139], a[68:71], v[104:107]
    v_perm_b32 v177, v238, v234, s74
    v_perm_b32 v181, v238, v234, s75
    v_mfma_f32_16x16x32_bf16 v[100:103], v[132:135], a[68:71], v[100:103]
    ds_read_b128 a[92:95], v15 offset:64512
    v_perm_b32 v185, v239, v235, s74
    v_mfma_f32_16x16x32_bf16 v[96:99], v[128:131], a[68:71], v[96:99]
    ds_read2_b32 v[8:9], v3 offset0:10 offset1:11
    ds_read2_b32 v[10:11], v4 offset0:10 offset1:11
    v_mfma_f32_16x16x32_bf16 a[0:3], v[128:131], a[72:75], a[0:3]
    ds_read2_b32 v[12:13], v5 offset0:10 offset1:11
    ds_read2_b32 v[14:15], v6 offset0:10 offset1:11
    v_mfma_f32_16x16x32_bf16 a[4:7], v[132:135], a[72:75], a[4:7]
    v_perm_b32 v189, v239, v235, s75
    s_waitcnt lgkmcnt(7)
    v_mad_u32_u24 v42, v42, v44, v45
    v_mfma_f32_16x16x32_bf16 a[8:11], v[136:139], a[72:75], a[8:11]
    buffer_load_dwordx4 v[232:235], v1, s[24:27], s69 offen offset:1024
    v_mfma_f32_16x16x32_bf16 a[12:15], v[140:143], a[72:75], a[12:15]
    v_mad_u32_u24 v43, v43, v44, v45
    s_waitcnt vmcnt(11)
    v_perm_b32 v162, v244, v240, s74
    v_mfma_f32_16x16x32_bf16 a[16:19], v[144:147], a[72:75], a[16:19]
    v_perm_b32 v166, v244, v240, s75
    v_perm_b32 v170, v245, v241, s74
    v_mfma_f32_16x16x32_bf16 a[20:23], v[148:151], a[72:75], a[20:23]
    v_perm_b32 v174, v245, v241, s75
    v_perm_b32 v178, v246, v242, s74
    v_mfma_f32_16x16x32_bf16 a[24:27], v[152:155], a[72:75], a[24:27]
    buffer_load_dwordx4 v[236:239], v1, s[24:27], s69 offen offset:1536
    v_mfma_f32_16x16x32_bf16 a[28:31], v[156:159], a[72:75], a[28:31]
    ds_read_b128 a[112:115], v42
    v_perm_b32 v182, v246, v242, s75
    v_mfma_f32_16x16x32_bf16 a[60:63], v[156:159], a[76:79], a[60:63]
    v_perm_b32 v186, v247, v243, s74
    v_perm_b32 v190, v247, v243, s75
    v_mfma_f32_16x16x32_bf16 a[56:59], v[152:155], a[76:79], a[56:59]
    ds_read_b128 a[116:119], v42 offset:64512
    v_perm_b32 v163, v252, v248, s74
    v_mfma_f32_16x16x32_bf16 a[52:55], v[148:151], a[76:79], a[52:55]
    buffer_load_dwordx4 v[240:243], v1, s[24:27], s69 offen offset:2048
    v_mfma_f32_16x16x32_bf16 a[48:51], v[144:147], a[76:79], a[48:51]
    v_perm_b32 v167, v252, v248, s75
    v_perm_b32 v171, v253, v249, s74
    v_mfma_f32_16x16x32_bf16 a[44:47], v[140:143], a[76:79], a[44:47]
    v_perm_b32 v175, v253, v249, s75
    v_perm_b32 v179, v254, v250, s74
    v_mfma_f32_16x16x32_bf16 a[40:43], v[136:139], a[76:79], a[40:43]
    ds_read_b128 a[120:123], v43
    v_perm_b32 v183, v254, v250, s75
    v_mfma_f32_16x16x32_bf16 a[36:39], v[132:135], a[76:79], a[36:39]
    buffer_load_dwordx4 v[244:247], v1, s[24:27], s69 offen offset:2560
    v_mfma_f32_16x16x32_bf16 a[32:35], v[128:131], a[76:79], a[32:35]
    ds_read_b128 a[124:127], v43 offset:64512
    v_perm_b32 v187, v255, v251, s74
    v_mfma_f32_16x16x32_bf16 v[64:67], v[160:163], a[80:83], v[64:67]
    v_perm_b32 v191, v255, v251, s75
    s_waitcnt lgkmcnt(4)
    v_lshl_add_u32 v8, v8, 6, v2
    v_mfma_f32_16x16x32_bf16 v[68:71], v[164:167], a[80:83], v[68:71]
    v_lshl_add_u32 v9, v9, 6, v2
    v_lshl_add_u32 v10, v10, 6, v2
    v_mfma_f32_16x16x32_bf16 v[72:75], v[168:171], a[80:83], v[72:75]
    buffer_load_dwordx4 v[248:251], v1, s[24:27], s69 offen offset:3072
    v_mfma_f32_16x16x32_bf16 v[76:79], v[172:175], a[80:83], v[76:79]
    v_lshl_add_u32 v11, v11, 6, v2
    v_lshl_add_u32 v12, v12, 6, v2
    v_mfma_f32_16x16x32_bf16 v[80:83], v[176:179], a[80:83], v[80:83]
    ds_read_b128 a[64:67], v8
    v_lshl_add_u32 v13, v13, 6, v2
    v_mfma_f32_16x16x32_bf16 v[84:87], v[180:183], a[80:83], v[84:87]
    s_waitcnt vmcnt(11)
    v_perm_b32 v128, v196, v192, s74
    v_perm_b32 v132, v196, v192, s75
    v_mfma_f32_16x16x32_bf16 v[88:91], v[184:187], a[80:83], v[88:91]
    buffer_load_dwordx4 v[252:255], v1, s[24:27], s69 offen offset:3584
    v_mfma_f32_16x16x32_bf16 v[92:95], v[188:191], a[80:83], v[92:95]
    v_perm_b32 v136, v197, v193, s74
    v_perm_b32 v140, v197, v193, s75
    v_mfma_f32_16x16x32_bf16 v[124:127], v[188:191], a[84:87], v[124:127]
    ds_read_b128 a[68:71], v10
    v_perm_b32 v144, v198, v194, s74
    v_mfma_f32_16x16x32_bf16 v[120:123], v[184:187], a[84:87], v[120:123]
    v_perm_b32 v148, v198, v194, s75
    v_perm_b32 v152, v199, v195, s74
    v_mfma_f32_16x16x32_bf16 v[116:119], v[180:183], a[84:87], v[116:119]
    v_perm_b32 v156, v199, v195, s75
    v_lshl_add_u32 v14, v14, 6, v2
    v_mfma_f32_16x16x32_bf16 v[112:115], v[176:179], a[84:87], v[112:115]
    buffer_load_dwordx4 v[192:195], v1, s[24:27], s70 offen
    v_mfma_f32_16x16x32_bf16 v[108:111], v[172:175], a[84:87], v[108:111]
    ds_read_b128 a[72:75], v12
    ds_read2_b32 v[40:41], v47 offset0:156 offset1:169
    v_mfma_f32_16x16x32_bf16 v[104:107], v[168:171], a[84:87], v[104:107]
    v_lshl_add_u32 v15, v15, 6, v2
    v_perm_b32 v129, v204, v200, s74
    v_mfma_f32_16x16x32_bf16 v[100:103], v[164:167], a[84:87], v[100:103]
    ds_read_b128 a[76:79], v14
    v_perm_b32 v133, v204, v200, s75
    v_mfma_f32_16x16x32_bf16 v[96:99], v[160:163], a[84:87], v[96:99]
    buffer_load_dwordx4 v[196:199], v1, s[24:27], s70 offen offset:512
    s_waitcnt lgkmcnt(5)
    v_mfma_f32_16x16x32_bf16 v[28:31], a[112:115], a[112:115], 0
    v_perm_b32 v137, v205, v201, s74
    v_perm_b32 v141, v205, v201, s75
    v_mfma_f32_16x16x32_bf16 v[28:31], a[116:119], a[116:119], v[28:31]
    v_perm_b32 v145, v206, v202, s74
    v_perm_b32 v149, v206, v202, s75
    v_mfma_f32_16x16x32_bf16 v[32:35], a[112:115], a[120:123], 0
    v_perm_b32 v153, v207, v203, s74
    v_perm_b32 v157, v207, v203, s75
    v_mfma_f32_16x16x32_bf16 v[32:35], a[116:119], a[124:127], v[32:35]
    buffer_load_dwordx4 v[200:203], v1, s[24:27], s70 offen offset:1024
    v_mfma_f32_16x16x32_bf16 v[36:39], a[120:123], a[120:123], 0
    s_waitcnt vmcnt(11)
    v_perm_b32 v130, v212, v208, s74
    v_perm_b32 v134, v212, v208, s75
    v_mfma_f32_16x16x32_bf16 v[36:39], a[124:127], a[124:127], v[36:39]
    v_perm_b32 v138, v213, v209, s74
    v_perm_b32 v142, v213, v209, s75
    v_mfma_f32_16x16x32_bf16 a[0:3], v[160:163], a[88:91], a[0:3]
    s_waitcnt lgkmcnt(1)
    v_mad_u32_u24 v40, v40, v44, v45
    v_mad_u32_u24 v41, v41, v44, v45
    v_mfma_f32_16x16x32_bf16 a[4:7], v[164:167], a[88:91], a[4:7]
    buffer_load_dwordx4 v[204:207], v1, s[24:27], s70 offen offset:1536
    v_mfma_f32_16x16x32_bf16 a[8:11], v[168:171], a[88:91], a[8:11]
    v_perm_b32 v146, v214, v210, s74
    v_perm_b32 v150, v214, v210, s75
    v_mfma_f32_16x16x32_bf16 a[12:15], v[172:175], a[88:91], a[12:15]
    v_perm_b32 v154, v215, v211, s74
    v_perm_b32 v158, v215, v211, s75
    v_mfma_f32_16x16x32_bf16 a[16:19], v[176:179], a[88:91], a[16:19]
    ds_read_b128 a[96:99], v40
    v_mul_f32 v49, v16, v28
    v_mfma_f32_16x16x32_bf16 a[20:23], v[180:183], a[88:91], a[20:23]
    buffer_load_dwordx4 v[208:211], v1, s[24:27], s70 offen offset:2048
    v_mfma_f32_16x16x32_bf16 a[24:27], v[184:187], a[88:91], a[24:27]
    ds_read_b128 a[100:103], v40 offset:64512
    v_perm_b32 v131, v220, v216, s74
    v_mfma_f32_16x16x32_bf16 a[28:31], v[188:191], a[88:91], a[28:31]
    v_perm_b32 v135, v220, v216, s75
    v_perm_b32 v139, v221, v217, s74
    v_mfma_f32_16x16x32_bf16 a[60:63], v[188:191], a[92:95], a[60:63]
    v_perm_b32 v143, v221, v217, s75
    v_perm_b32 v147, v222, v218, s74
    v_mfma_f32_16x16x32_bf16 a[56:59], v[184:187], a[92:95], a[56:59]
    buffer_load_dwordx4 v[212:215], v1, s[24:27], s70 offen offset:2560
    v_mfma_f32_16x16x32_bf16 a[52:55], v[180:183], a[92:95], a[52:55]
    v_perm_b32 v151, v222, v218, s75
    v_perm_b32 v155, v223, v219, s74
    v_mfma_f32_16x16x32_bf16 a[48:51], v[176:179], a[92:95], a[48:51]
    ds_read_b128 a[104:107], v41
    v_perm_b32 v159, v223, v219, s75
    v_mfma_f32_16x16x32_bf16 a[44:47], v[172:175], a[92:95], a[44:47]
    v_fmac_f32 v49, v17, v29
    v_fmac_f32 v49, v18, v30
    v_mfma_f32_16x16x32_bf16 a[40:43], v[168:171], a[92:95], a[40:43]
    buffer_load_dwordx4 v[216:219], v1, s[24:27], s70 offen offset:3072
    v_mfma_f32_16x16x32_bf16 a[36:39], v[164:167], a[92:95], a[36:39]
    ds_read_b128 a[108:111], v41 offset:64512
    v_fmac_f32 v49, v19, v31
    v_mfma_f32_16x16x32_bf16 a[32:35], v[160:163], a[92:95], a[32:35]
    v_fmac_f32 v49, v20, v32
    v_fmac_f32 v49, v21, v33
    v_mfma_f32_16x16x32_bf16 v[64:67], v[128:131], a[64:67], v[64:67]
    v_fmac_f32 v49, v22, v34
    v_fmac_f32 v49, v23, v35
    v_mfma_f32_16x16x32_bf16 v[68:71], v[132:135], a[64:67], v[68:71]
    buffer_load_dwordx4 v[220:223], v1, s[24:27], s70 offen offset:3584
    v_mfma_f32_16x16x32_bf16 v[72:75], v[136:139], a[64:67], v[72:75]
    ds_read_b128 a[80:83], v8 offset:64512
    v_fmac_f32 v49, v24, v36
    v_mfma_f32_16x16x32_bf16 v[76:79], v[140:143], a[64:67], v[76:79]
    v_fmac_f32 v49, v25, v37
    v_fmac_f32 v49, v26, v38
    v_mfma_f32_16x16x32_bf16 v[80:83], v[144:147], a[64:67], v[80:83]
    v_fmac_f32 v49, v27, v39
    s_waitcnt vmcnt(12)
    v_perm_b32 v160, v228, v224, s74
    v_mfma_f32_16x16x32_bf16 v[84:87], v[148:151], a[64:67], v[84:87]
    v_perm_b32 v164, v228, v224, s75
    v_perm_b32 v168, v229, v225, s74
    v_mfma_f32_16x16x32_bf16 v[88:91], v[152:155], a[64:67], v[88:91]
    v_perm_b32 v172, v229, v225, s75
    v_perm_b32 v176, v230, v226, s74
    v_mfma_f32_16x16x32_bf16 v[92:95], v[156:159], a[64:67], v[92:95]
    v_perm_b32 v180, v230, v226, s75
    v_perm_b32 v184, v231, v227, s74
    v_mfma_f32_16x16x32_bf16 v[124:127], v[156:159], a[68:71], v[124:127]
    ds_read_b128 a[84:87], v10 offset:64512
    v_perm_b32 v188, v231, v227, s75
    v_mfma_f32_16x16x32_bf16 v[120:123], v[152:155], a[68:71], v[120:123]
    buffer_load_dwordx4 v[224:227], v1, s[24:27], s71 offen
    v_mfma_f32_16x16x32_bf16 v[116:119], v[148:151], a[68:71], v[116:119]
    ds_read_b128 a[88:91], v12 offset:64512
    v_perm_b32 v161, v236, v232, s74
    v_mfma_f32_16x16x32_bf16 v[112:115], v[144:147], a[68:71], v[112:115]
    v_perm_b32 v165, v236, v232, s75
    v_perm_b32 v169, v237, v233, s74
    v_mfma_f32_16x16x32_bf16 v[108:111], v[140:143], a[68:71], v[108:111]
    ds_read_b128 a[92:95], v14 offset:64512
    v_perm_b32 v173, v237, v233, s75
    v_mfma_f32_16x16x32_bf16 v[104:107], v[136:139], a[68:71], v[104:107]
    buffer_load_dwordx4 v[228:231], v1, s[24:27], s71 offen offset:512
    v_mfma_f32_16x16x32_bf16 v[100:103], v[132:135], a[68:71], v[100:103]
    v_perm_b32 v177, v238, v234, s74
    v_perm_b32 v181, v238, v234, s75
    v_mfma_f32_16x16x32_bf16 v[96:99], v[128:131], a[68:71], v[96:99]
    v_perm_b32 v185, v239, v235, s74
    v_perm_b32 v189, v239, v235, s75
    s_waitcnt lgkmcnt(4)
    v_mfma_f32_16x16x32_bf16 v[28:31], a[96:99], a[96:99], 0
    v_permlane32_swap_b32 v48, v49
    v_mfma_f32_16x16x32_bf16 v[28:31], a[100:103], a[100:103], v[28:31]
    buffer_load_dwordx4 v[232:235], v1, s[24:27], s71 offen offset:1024
    v_mfma_f32_16x16x32_bf16 v[32:35], a[96:99], a[104:107], 0
    s_waitcnt vmcnt(11)
    v_perm_b32 v162, v244, v240, s74
    v_perm_b32 v166, v244, v240, s75
    v_mfma_f32_16x16x32_bf16 v[32:35], a[100:103], a[108:111], v[32:35]
    v_perm_b32 v170, v245, v241, s74
    v_perm_b32 v174, v245, v241, s75
    v_mfma_f32_16x16x32_bf16 v[36:39], a[104:107], a[104:107], 0
    v_perm_b32 v178, v246, v242, s74
    v_perm_b32 v182, v246, v242, s75
    v_mfma_f32_16x16x32_bf16 v[36:39], a[108:111], a[108:111], v[36:39]
    buffer_load_dwordx4 v[236:239], v1, s[24:27], s71 offen offset:1536
    v_mfma_f32_16x16x32_bf16 a[0:3], v[128:131], a[72:75], a[0:3]
    v_perm_b32 v186, v247, v243, s74
    v_perm_b32 v190, v247, v243, s75
    v_mfma_f32_16x16x32_bf16 a[4:7], v[132:135], a[72:75], a[4:7]
    v_mul_f32 v50, v16, v28
    v_fmac_f32 v50, v17, v29
    v_mfma_f32_16x16x32_bf16 a[8:11], v[136:139], a[72:75], a[8:11]
    v_fmac_f32 v50, v18, v30
    v_fmac_f32 v50, v19, v31
    v_mfma_f32_16x16x32_bf16 a[12:15], v[140:143], a[72:75], a[12:15]
    buffer_load_dwordx4 v[240:243], v1, s[24:27], s71 offen offset:2048
    v_mfma_f32_16x16x32_bf16 a[16:19], v[144:147], a[72:75], a[16:19]
    v_fmac_f32 v50, v20, v32
    v_fmac_f32 v50, v21, v33
    v_mfma_f32_16x16x32_bf16 a[20:23], v[148:151], a[72:75], a[20:23]
    v_perm_b32 v163, v252, v248, s74
    v_perm_b32 v167, v252, v248, s75
    v_mfma_f32_16x16x32_bf16 a[24:27], v[152:155], a[72:75], a[24:27]
    v_perm_b32 v171, v253, v249, s74
    v_perm_b32 v175, v253, v249, s75
    v_mfma_f32_16x16x32_bf16 a[28:31], v[156:159], a[72:75], a[28:31]
    buffer_load_dwordx4 v[244:247], v1, s[24:27], s71 offen offset:2560
    v_mfma_f32_16x16x32_bf16 a[60:63], v[156:159], a[76:79], a[60:63]
    v_perm_b32 v179, v254, v250, s74
    v_perm_b32 v183, v254, v250, s75
    v_mfma_f32_16x16x32_bf16 a[56:59], v[152:155], a[76:79], a[56:59]
    v_perm_b32 v187, v255, v251, s74
    v_perm_b32 v191, v255, v251, s75
    v_mfma_f32_16x16x32_bf16 a[52:55], v[148:151], a[76:79], a[52:55]
    v_fmac_f32 v50, v22, v34
    v_fmac_f32 v50, v23, v35
    v_mfma_f32_16x16x32_bf16 a[48:51], v[144:147], a[76:79], a[48:51]
    buffer_load_dwordx4 v[248:251], v1, s[24:27], s71 offen offset:3072
    v_mfma_f32_16x16x32_bf16 a[44:47], v[140:143], a[76:79], a[44:47]
    v_fmac_f32 v50, v24, v36
    v_fmac_f32 v50, v25, v37
    v_mfma_f32_16x16x32_bf16 a[40:43], v[136:139], a[76:79], a[40:43]
    v_fmac_f32 v50, v26, v38
    v_fmac_f32 v50, v27, v39
    v_mfma_f32_16x16x32_bf16 a[36:39], v[132:135], a[76:79], a[36:39]
    v_add_f32 v48, v48, v49
    v_mfma_f32_16x16x32_bf16 a[32:35], v[128:131], a[76:79], a[32:35]
    buffer_load_dwordx4 v[252:255], v1, s[24:27], s71 offen offset:3584
    s_waitcnt lgkmcnt(0)
    v_mfma_f32_16x16x32_bf16 v[64:67], v[160:163], a[80:83], v[64:67]
    s_waitcnt vmcnt(12)
    v_perm_b32 v128, v196, v192, s74
    v_perm_b32 v132, v196, v192, s75
    v_mfma_f32_16x16x32_bf16 v[68:71], v[164:167], a[80:83], v[68:71]
    v_perm_b32 v136, v197, v193, s74
    v_perm_b32 v140, v197, v193, s75
    v_mfma_f32_16x16x32_bf16 v[72:75], v[168:171], a[80:83], v[72:75]
    v_perm_b32 v144, v198, v194, s74
    v_perm_b32 v148, v198, v194, s75
    v_mfma_f32_16x16x32_bf16 v[76:79], v[172:175], a[80:83], v[76:79]
    v_perm_b32 v152, v199, v195, s74
    v_perm_b32 v156, v199, v195, s75
    v_mfma_f32_16x16x32_bf16 v[80:83], v[176:179], a[80:83], v[80:83]
    ds_read_b128 a[64:67], v9
    ds_read2_b32 v[42:43], v47 offset0:182 offset1:195
    v_mfma_f32_16x16x32_bf16 v[84:87], v[180:183], a[80:83], v[84:87]
    buffer_load_dwordx4 v[192:195], v1, s[24:27], s72 offen
    v_mfma_f32_16x16x32_bf16 v[88:91], v[184:187], a[80:83], v[88:91]
    ds_read_b128 a[68:71], v11
    v_mfma_f32_16x16x32_bf16 v[92:95], v[188:191], a[80:83], v[92:95]
    v_perm_b32 v129, v204, v200, s74
    v_perm_b32 v133, v204, v200, s75
    v_mfma_f32_16x16x32_bf16 v[124:127], v[188:191], a[84:87], v[124:127]
    ds_read_b128 a[72:75], v13
    v_perm_b32 v137, v205, v201, s74
    v_mfma_f32_16x16x32_bf16 v[120:123], v[184:187], a[84:87], v[120:123]
    buffer_load_dwordx4 v[196:199], v1, s[24:27], s72 offen offset:512
    v_mfma_f32_16x16x32_bf16 v[116:119], v[180:183], a[84:87], v[116:119]
    v_perm_b32 v141, v205, v201, s75
    v_perm_b32 v145, v206, v202, s74
    v_mfma_f32_16x16x32_bf16 v[112:115], v[176:179], a[84:87], v[112:115]
    v_perm_b32 v149, v206, v202, s75
    v_perm_b32 v153, v207, v203, s74
    v_mfma_f32_16x16x32_bf16 v[108:111], v[172:175], a[84:87], v[108:111]
    ds_read_b128 a[76:79], v15
    v_perm_b32 v157, v207, v203, s75
    v_mfma_f32_16x16x32_bf16 v[104:107], v[168:171], a[84:87], v[104:107]
    buffer_load_dwordx4 v[200:203], v1, s[24:27], s72 offen offset:1024
    v_mfma_f32_16x16x32_bf16 v[100:103], v[164:167], a[84:87], v[100:103]
    s_waitcnt lgkmcnt(3)
    v_mad_u32_u24 v42, v42, v44, v45
    v_mad_u32_u24 v43, v43, v44, v45
    v_mfma_f32_16x16x32_bf16 v[96:99], v[160:163], a[84:87], v[96:99]
    s_waitcnt vmcnt(11)
    v_perm_b32 v130, v212, v208, s74
    v_perm_b32 v134, v212, v208, s75
    v_mfma_f32_16x16x32_bf16 a[0:3], v[160:163], a[88:91], a[0:3]
    v_perm_b32 v138, v213, v209, s74
    v_perm_b32 v142, v213, v209, s75
    v_mfma_f32_16x16x32_bf16 a[4:7], v[164:167], a[88:91], a[4:7]
    buffer_load_dwordx4 v[204:207], v1, s[24:27], s72 offen offset:1536
    v_mfma_f32_16x16x32_bf16 a[8:11], v[168:171], a[88:91], a[8:11]
    v_perm_b32 v146, v214, v210, s74
    v_perm_b32 v150, v214, v210, s75
    v_mfma_f32_16x16x32_bf16 a[12:15], v[172:175], a[88:91], a[12:15]
    v_perm_b32 v154, v215, v211, s74
    v_perm_b32 v158, v215, v211, s75
    v_mfma_f32_16x16x32_bf16 a[16:19], v[176:179], a[88:91], a[16:19]
    ds_read_b128 a[112:115], v42
    v_mfma_f32_16x16x32_bf16 a[20:23], v[180:183], a[88:91], a[20:23]
    buffer_load_dwordx4 v[208:211], v1, s[24:27], s72 offen offset:2048
    v_mfma_f32_16x16x32_bf16 a[24:27], v[184:187], a[88:91], a[24:27]
    ds_read_b128 a[116:119], v42 offset:64512
    v_mfma_f32_16x16x32_bf16 a[28:31], v[188:191], a[88:91], a[28:31]
    v_perm_b32 v131, v220, v216, s74
    v_perm_b32 v135, v220, v216, s75
    v_mfma_f32_16x16x32_bf16 a[60:63], v[188:191], a[92:95], a[60:63]
    v_perm_b32 v139, v221, v217, s74
    v_perm_b32 v143, v221, v217, s75
    v_mfma_f32_16x16x32_bf16 a[56:59], v[184:187], a[92:95], a[56:59]
    buffer_load_dwordx4 v[212:215], v1, s[24:27], s72 offen offset:2560
    v_mfma_f32_16x16x32_bf16 a[52:55], v[180:183], a[92:95], a[52:55]
    v_perm_b32 v147, v222, v218, s74
    v_perm_b32 v151, v222, v218, s75
    v_mfma_f32_16x16x32_bf16 a[48:51], v[176:179], a[92:95], a[48:51]
    v_perm_b32 v155, v223, v219, s74
    v_perm_b32 v159, v223, v219, s75
    v_mfma_f32_16x16x32_bf16 a[44:47], v[172:175], a[92:95], a[44:47]
    ds_read_b128 a[120:123], v43
    v_mfma_f32_16x16x32_bf16 a[40:43], v[168:171], a[92:95], a[40:43]
    buffer_load_dwordx4 v[216:219], v1, s[24:27], s72 offen offset:3072
    v_mfma_f32_16x16x32_bf16 a[36:39], v[164:167], a[92:95], a[36:39]
    ds_read_b128 a[124:127], v43 offset:64512
    v_mfma_f32_16x16x32_bf16 a[32:35], v[160:163], a[92:95], a[32:35]
    s_waitcnt vmcnt(11)
    v_perm_b32 v160, v228, v224, s74
    v_perm_b32 v164, v228, v224, s75
    v_mfma_f32_16x16x32_bf16 v[64:67], v[128:131], a[64:67], v[64:67]
    v_perm_b32 v168, v229, v225, s74
    v_perm_b32 v172, v229, v225, s75
    v_mfma_f32_16x16x32_bf16 v[68:71], v[132:135], a[64:67], v[68:71]
    buffer_load_dwordx4 v[220:223], v1, s[24:27], s72 offen offset:3584
    v_mfma_f32_16x16x32_bf16 v[72:75], v[136:139], a[64:67], v[72:75]
    ds_read_b128 a[80:83], v9 offset:64512
    v_perm_b32 v176, v230, v226, s74
    v_mfma_f32_16x16x32_bf16 v[76:79], v[140:143], a[64:67], v[76:79]
    v_perm_b32 v180, v230, v226, s75
    v_perm_b32 v184, v231, v227, s74
    v_mfma_f32_16x16x32_bf16 v[80:83], v[144:147], a[64:67], v[80:83]
    ds_read_b32 v8, v3 offset:48
    v_perm_b32 v188, v231, v227, s75
    v_mfma_f32_16x16x32_bf16 v[84:87], v[148:151], a[64:67], v[84:87]
    buffer_load_dwordx4 v[224:227], v1, s[24:27], s73 offen
    v_mfma_f32_16x16x32_bf16 v[88:91], v[152:155], a[64:67], v[88:91]
    ds_read_b128 a[84:87], v11 offset:64512
    ds_read_b32 v10, v4 offset:48
    v_mfma_f32_16x16x32_bf16 v[92:95], v[156:159], a[64:67], v[92:95]
    s_waitcnt lgkmcnt(6)
    v_mfma_f32_16x16x32_bf16 v[124:127], v[156:159], a[68:71], v[124:127]
    ds_read_b128 a[88:91], v13 offset:64512
    v_perm_b32 v161, v236, v232, s74
    v_mfma_f32_16x16x32_bf16 v[120:123], v[152:155], a[68:71], v[120:123]
    buffer_load_dwordx4 v[228:231], v1, s[24:27], s73 offen offset:512
    v_mfma_f32_16x16x32_bf16 v[116:119], v[148:151], a[68:71], v[116:119]
    ds_read_b32 v12, v5 offset:48
    v_perm_b32 v165, v236, v232, s75
    v_mfma_f32_16x16x32_bf16 v[112:115], v[144:147], a[68:71], v[112:115]
    ds_read_b128 a[92:95], v15 offset:64512
    v_perm_b32 v169, v237, v233, s74
    v_mfma_f32_16x16x32_bf16 v[108:111], v[140:143], a[68:71], v[108:111]
    ds_read_b32 v14, v6 offset:48
    v_perm_b32 v173, v237, v233, s75
    v_mfma_f32_16x16x32_bf16 v[104:107], v[136:139], a[68:71], v[104:107]
    v_perm_b32 v177, v238, v234, s74
    v_perm_b32 v181, v238, v234, s75
    v_mfma_f32_16x16x32_bf16 v[100:103], v[132:135], a[68:71], v[100:103]
    v_perm_b32 v185, v239, v235, s74
    v_perm_b32 v189, v239, v235, s75
    v_mfma_f32_16x16x32_bf16 v[96:99], v[128:131], a[68:71], v[96:99]
    buffer_load_dwordx4 v[232:235], v1, s[24:27], s73 offen offset:1024
    v_mfma_f32_16x16x32_bf16 v[28:31], a[112:115], a[112:115], 0
    s_waitcnt lgkmcnt(6)
    v_lshl_add_u32 v8, v8, 6, v2
    s_waitcnt lgkmcnt(4)
    v_lshl_add_u32 v10, v10, 6, v2
    v_mfma_f32_16x16x32_bf16 v[28:31], a[116:119], a[116:119], v[28:31]
    v_mfma_f32_16x16x32_bf16 v[32:35], a[112:115], a[120:123], 0
    s_waitcnt vmcnt(11)
    v_perm_b32 v162, v244, v240, s74
    v_perm_b32 v166, v244, v240, s75
    v_mfma_f32_16x16x32_bf16 v[32:35], a[116:119], a[124:127], v[32:35]
    buffer_load_dwordx4 v[236:239], v1, s[24:27], s73 offen offset:1536
    v_mfma_f32_16x16x32_bf16 v[36:39], a[120:123], a[120:123], 0
    v_perm_b32 v170, v245, v241, s74
    v_perm_b32 v174, v245, v241, s75
    v_mfma_f32_16x16x32_bf16 v[36:39], a[124:127], a[124:127], v[36:39]
    v_perm_b32 v178, v246, v242, s74
    v_perm_b32 v182, v246, v242, s75
    v_mfma_f32_16x16x32_bf16 a[0:3], v[128:131], a[72:75], a[0:3]
    v_perm_b32 v186, v247, v243, s74
    v_perm_b32 v190, v247, v243, s75
    v_mfma_f32_16x16x32_bf16 a[4:7], v[132:135], a[72:75], a[4:7]
    buffer_load_dwordx4 v[240:243], v1, s[24:27], s73 offen offset:2048
    v_mfma_f32_16x16x32_bf16 a[8:11], v[136:139], a[72:75], a[8:11]
    v_mul_f32 v51, v16, v28
    v_fmac_f32 v51, v17, v29
    v_mfma_f32_16x16x32_bf16 a[12:15], v[140:143], a[72:75], a[12:15]
    v_fmac_f32 v51, v18, v30
    v_fmac_f32 v51, v19, v31
    v_mfma_f32_16x16x32_bf16 a[16:19], v[144:147], a[72:75], a[16:19]
    v_fmac_f32 v51, v20, v32
    v_fmac_f32 v51, v21, v33
    v_mfma_f32_16x16x32_bf16 a[20:23], v[148:151], a[72:75], a[20:23]
    buffer_load_dwordx4 v[244:247], v1, s[24:27], s73 offen offset:2560
    v_mfma_f32_16x16x32_bf16 a[24:27], v[152:155], a[72:75], a[24:27]
    v_perm_b32 v163, v252, v248, s74
    v_perm_b32 v167, v252, v248, s75
    v_mfma_f32_16x16x32_bf16 a[28:31], v[156:159], a[72:75], a[28:31]
    v_perm_b32 v171, v253, v249, s74
    v_perm_b32 v175, v253, v249, s75
    v_mfma_f32_16x16x32_bf16 a[60:63], v[156:159], a[76:79], a[60:63]
    v_perm_b32 v179, v254, v250, s74
    v_perm_b32 v183, v254, v250, s75
    v_mfma_f32_16x16x32_bf16 a[56:59], v[152:155], a[76:79], a[56:59]
    buffer_load_dword v54, v54, s[44:47], 0 offen offset:128 sc1
    v_mfma_f32_16x16x32_bf16 a[52:55], v[148:151], a[76:79], a[52:55]
    v_perm_b32 v187, v255, v251, s74
    v_perm_b32 v191, v255, v251, s75
    v_mfma_f32_16x16x32_bf16 a[48:51], v[144:147], a[76:79], a[48:51]
    v_fmac_f32 v51, v22, v34
    v_fmac_f32 v51, v23, v35
    v_mfma_f32_16x16x32_bf16 a[44:47], v[140:143], a[76:79], a[44:47]
    s_waitcnt lgkmcnt(0)
    v_lshl_add_u32 v12, v12, 6, v2
    v_fmac_f32 v51, v24, v36
    v_mfma_f32_16x16x32_bf16 a[40:43], v[136:139], a[76:79], a[40:43]
    buffer_load_dwordx4 v[248:251], v1, s[24:27], s73 offen offset:3072
    v_mfma_f32_16x16x32_bf16 a[36:39], v[132:135], a[76:79], a[36:39]
    v_fmac_f32 v51, v25, v37
    v_fmac_f32 v51, v26, v38
    v_mfma_f32_16x16x32_bf16 a[32:35], v[128:131], a[76:79], a[32:35]
    s_waitcnt vmcnt(12)
    v_perm_b32 v128, v196, v192, s74
    v_perm_b32 v132, v196, v192, s75
    v_mfma_f32_16x16x32_bf16 v[64:67], v[160:163], a[80:83], v[64:67]
    v_perm_b32 v136, v197, v193, s74
    v_perm_b32 v140, v197, v193, s75
    v_mfma_f32_16x16x32_bf16 v[68:71], v[164:167], a[80:83], v[68:71]
    buffer_load_dwordx4 v[252:255], v1, s[24:27], s73 offen offset:3584
    v_mfma_f32_16x16x32_bf16 v[72:75], v[168:171], a[80:83], v[72:75]
    v_perm_b32 v144, v198, v194, s74
    v_perm_b32 v148, v198, v194, s75
    v_mfma_f32_16x16x32_bf16 v[76:79], v[172:175], a[80:83], v[76:79]
    v_perm_b32 v152, v199, v195, s74
    v_perm_b32 v156, v199, v195, s75
    v_mfma_f32_16x16x32_bf16 v[80:83], v[176:179], a[80:83], v[80:83]
    ds_read_b128 a[64:67], v8
    v_fmac_f32 v51, v27, v39
    v_mfma_f32_16x16x32_bf16 v[84:87], v[180:183], a[80:83], v[84:87]
    v_perm_b32 v129, v204, v200, s74
    v_perm_b32 v133, v204, v200, s75
    v_mfma_f32_16x16x32_bf16 v[88:91], v[184:187], a[80:83], v[88:91]
    v_perm_b32 v137, v205, v201, s74
    v_perm_b32 v141, v205, v201, s75
    v_mfma_f32_16x16x32_bf16 v[92:95], v[188:191], a[80:83], v[92:95]
    v_perm_b32 v145, v206, v202, s74
    v_perm_b32 v149, v206, v202, s75
    v_mfma_f32_16x16x32_bf16 v[124:127], v[188:191], a[84:87], v[124:127]
    ds_read_b128 a[68:71], v10
    v_perm_b32 v153, v207, v203, s74
    v_mfma_f32_16x16x32_bf16 v[120:123], v[184:187], a[84:87], v[120:123]
    v_perm_b32 v157, v207, v203, s75
    v_lshl_add_u32 v14, v14, 6, v2
    v_mfma_f32_16x16x32_bf16 v[116:119], v[180:183], a[84:87], v[116:119]
    s_waitcnt vmcnt(9)
    v_perm_b32 v130, v212, v208, s74
    v_perm_b32 v134, v212, v208, s75
    v_mfma_f32_16x16x32_bf16 v[112:115], v[176:179], a[84:87], v[112:115]
    ds_read_b128 a[72:75], v12
    v_perm_b32 v138, v213, v209, s74
    v_mfma_f32_16x16x32_bf16 v[108:111], v[172:175], a[84:87], v[108:111]
    v_perm_b32 v142, v213, v209, s75
    v_perm_b32 v146, v214, v210, s74
    v_mfma_f32_16x16x32_bf16 v[104:107], v[168:171], a[84:87], v[104:107]
    ds_read_b128 a[128:131], v8 offset:64512
    v_perm_b32 v150, v214, v210, s75
    v_mfma_f32_16x16x32_bf16 v[100:103], v[164:167], a[84:87], v[100:103]
    v_perm_b32 v154, v215, v211, s74
    v_perm_b32 v158, v215, v211, s75
    v_mfma_f32_16x16x32_bf16 v[96:99], v[160:163], a[84:87], v[96:99]
    ds_read_b128 a[76:79], v14
    v_perm_b32 v131, v220, v216, s74
    v_mfma_f32_16x16x32_bf16 a[0:3], v[160:163], a[88:91], a[0:3]
    v_perm_b32 v135, v220, v216, s75
    v_perm_b32 v139, v221, v217, s74
    v_mfma_f32_16x16x32_bf16 a[4:7], v[164:167], a[88:91], a[4:7]
    ds_read_b128 a[132:135], v10 offset:64512
    v_perm_b32 v143, v221, v217, s75
    v_mfma_f32_16x16x32_bf16 a[8:11], v[168:171], a[88:91], a[8:11]
    v_perm_b32 v147, v222, v218, s74
    v_perm_b32 v151, v222, v218, s75
    v_mfma_f32_16x16x32_bf16 a[12:15], v[172:175], a[88:91], a[12:15]
L_hop4:
    s_cbranch_execz L_hopback
    ds_read_b128 a[136:139], v12 offset:64512
    v_perm_b32 v155, v223, v219, s74
    v_mfma_f32_16x16x32_bf16 a[16:19], v[176:179], a[88:91], a[16:19]
    v_perm_b32 v159, v223, v219, s75
    s_waitcnt vmcnt(7)
    v_perm_b32 v192, v228, v224, s74
    v_mfma_f32_16x16x32_bf16 a[20:23], v[180:183], a[88:91], a[20:23]
    ds_read_b128 a[140:143], v14 offset:64512
    v_perm_b32 v196, v228, v224, s75
    v_mfma_f32_16x16x32_bf16 a[24:27], v[184:187], a[88:91], a[24:27]
    v_perm_b32 v200, v229, v225, s74
    s_waitcnt vmcnt(5)
    v_perm_b32 v193, v236, v232, s74
    v_mfma_f32_16x16x32_bf16 a[28:31], v[188:191], a[88:91], a[28:31]
    v_permlane32_swap_b32 v50, v51
    v_mfma_f32_16x16x32_bf16 a[60:63], v[188:191], a[92:95], a[60:63]
    v_add_f32 v50, v50, v51
    v_perm_b32 v204, v229, v225, s75
    v_mfma_f32_16x16x32_bf16 a[56:59], v[184:187], a[92:95], a[56:59]
    v_permlane16_swap_b32 v48, v50
    v_mfma_f32_16x16x32_bf16 a[52:55], v[180:183], a[92:95], a[52:55]
    v_add_f32 v48, v48, v50
    v_perm_b32 v197, v236, v232, s75
    v_mfma_f32_16x16x32_bf16 a[48:51], v[176:179], a[92:95], a[48:51]
    v_add_f32_dpp v48, v48, v48 row_ror:8 row_mask:0xf bank_mask:0xf
    v_perm_b32 v208, v230, v226, s74
    v_mfma_f32_16x16x32_bf16 a[44:47], v[172:175], a[92:95], a[44:47]
    v_add_f32_dpp v48, v48, v48 row_ror:4 row_mask:0xf bank_mask:0xf
    v_perm_b32 v201, v237, v233, s74
    v_mfma_f32_16x16x32_bf16 a[40:43], v[168:171], a[92:95], a[40:43]
    v_add_f32_dpp v48, v48, v48 row_ror:2 row_mask:0xf bank_mask:0xf
    s_waitcnt vmcnt(3)
    v_perm_b32 v194, v244, v240, s74
    v_mfma_f32_16x16x32_bf16 a[36:39], v[164:167], a[92:95], a[36:39]
    v_add_f32_dpp v48, v48, v48 row_ror:1 row_mask:0xf bank_mask:0xf
    v_perm_b32 v212, v230, v226, s75
    v_mfma_f32_16x16x32_bf16 a[32:35], v[160:163], a[92:95], a[32:35]
    ds_write_b32 v59, v48 offset:48
    v_perm_b32 v205, v237, v233, s75
    s_waitcnt lgkmcnt(1)
    s_barrier
    v_perm_b32 v198, v244, v240, s75
    v_perm_b32 v216, v231, v227, s74
    v_mfma_f32_16x16x32_bf16 a[0:3], v[128:131], a[72:75], a[0:3]
    v_perm_b32 v209, v238, v234, s74
    v_perm_b32 v202, v245, v241, s74
    s_waitcnt vmcnt(0)
    v_perm_b32 v195, v252, v248, s74
    s_nop 1
    v_mfma_f32_16x16x32_bf16 a[0:3], v[192:195], a[136:139], a[0:3]
    v_perm_b32 v220, v231, v227, s75
    v_perm_b32 v213, v238, v234, s75
    v_perm_b32 v199, v252, v248, s75
    s_nop 1
    v_mfma_f32_16x16x32_bf16 a[4:7], v[196:199], a[136:139], a[4:7]
    v_perm_b32 v206, v245, v241, s75
    v_perm_b32 v217, v239, v235, s74
    v_mfma_f32_16x16x32_bf16 a[4:7], v[132:135], a[72:75], a[4:7]
    v_perm_b32 v210, v246, v242, s74
    v_perm_b32 v203, v253, v249, s74
    v_mfma_f32_16x16x32_bf16 a[8:11], v[136:139], a[72:75], a[8:11]
    v_perm_b32 v221, v239, v235, s75
    v_perm_b32 v214, v246, v242, s75
    v_mfma_f32_16x16x32_bf16 a[8:11], v[200:203], a[136:139], a[8:11]
    ds_write_b128 v56, a[0:3]
    v_perm_b32 v207, v253, v249, s75
    s_nop 1
    v_mfma_f32_16x16x32_bf16 a[12:15], v[204:207], a[136:139], a[12:15]
    v_perm_b32 v218, v247, v243, s74
    v_perm_b32 v211, v254, v250, s74
    v_mfma_f32_16x16x32_bf16 a[12:15], v[140:143], a[72:75], a[12:15]
    v_perm_b32 v222, v247, v243, s75
    v_perm_b32 v215, v254, v250, s75
    v_mfma_f32_16x16x32_bf16 a[16:19], v[144:147], a[72:75], a[16:19]
    ds_write_b128 v56, a[4:7] offset:1024
    v_mfma_f32_16x16x32_bf16 a[16:19], v[208:211], a[136:139], a[16:19]
    ds_read_b32 v55, v58
    v_add_u32 v13, 0x5bd1e995, v53
    v_mfma_f32_16x16x32_bf16 a[20:23], v[212:215], a[136:139], a[20:23]
    v_cmp_eq_u32 vcc, v54, v13
    v_add_u32 v9, 1, v53
    v_mfma_f32_16x16x32_bf16 a[20:23], v[148:151], a[72:75], a[20:23]
    ds_write_b128 v56, a[8:11] offset:2048
    v_mfma_f32_16x16x32_bf16 a[24:27], v[152:155], a[72:75], a[24:27]
    v_perm_b32 v219, v255, v251, s74
    s_and_b32 s61, vcc_lo, s3
    v_perm_b32 v223, v255, v251, s75
    v_mfma_f32_16x16x32_bf16 a[24:27], v[216:219], a[136:139], a[24:27]
    v_and_b32 v13, 48, v0
    v_cmp_eq_u32 vcc, 0, v13
    v_mfma_f32_16x16x32_bf16 a[28:31], v[220:223], a[136:139], a[28:31]
    ds_write_b128 v56, a[12:15] offset:3072
    v_mfma_f32_16x16x32_bf16 a[28:31], v[156:159], a[72:75], a[28:31]
    v_mov_b32 v14, 0x7fff0000
    v_and_b32 v12, 63, v0
    v_mfma_f32_16x16x32_bf16 a[32:35], v[128:131], a[76:79], a[32:35]
    v_cndmask_b32 v54, v14, v52, vcc
    v_subrev_u32 v12, 16, v12
    v_mfma_f32_16x16x32_bf16 a[32:35], v[192:195], a[140:143], a[32:35]
    ds_write_b128 v56, a[16:19] offset:4096
    v_mfma_f32_16x16x32_bf16 a[36:39], v[196:199], a[140:143], a[36:39]
    v_lshlrev_b32 v12, 1, v12
    v_cmp_gt_u32 vcc, 32, v12
    v_mfma_f32_16x16x32_bf16 a[36:39], v[132:135], a[76:79], a[36:39]
    s_lshl_b32 s43, s2, 7
    s_waitcnt lgkmcnt(3)
    v_add_f32 v55, s80, v55
    s_lshl_b32 s62, s76, 5
    s_add_u32 s43, s43, s62
    s_mov_b32 s62, 0
    v_cndmask_b32 v12, v14, v12, vcc
    v_mfma_f32_16x16x32_bf16 a[40:43], v[136:139], a[76:79], a[40:43]
    v_mfma_f32_16x16x32_bf16 a[40:43], v[200:203], a[140:143], a[40:43]
    ds_write_b128 v56, a[20:23] offset:5120
    v_mfma_f32_16x16x32_bf16 a[44:47], v[204:207], a[140:143], a[44:47]
    v_mfma_f32_16x16x32_bf16 a[44:47], v[140:143], a[76:79], a[44:47]
    v_mfma_f32_16x16x32_bf16 a[48:51], v[144:147], a[76:79], a[48:51]
    ds_write_b128 v56, a[24:27] offset:6144
    v_mfma_f32_16x16x32_bf16 a[48:51], v[208:211], a[140:143], a[48:51]
    v_mfma_f32_16x16x32_bf16 a[52:55], v[212:215], a[140:143], a[52:55]
    v_mfma_f32_16x16x32_bf16 a[52:55], v[148:151], a[76:79], a[52:55]
    ds_write_b128 v56, a[28:31] offset:7168
    v_mfma_f32_16x16x32_bf16 a[56:59], v[152:155], a[76:79], a[56:59]
    v_mfma_f32_16x16x32_bf16 a[56:59], v[216:219], a[140:143], a[56:59]
    v_mfma_f32_16x16x32_bf16 a[60:63], v[220:223], a[140:143], a[60:63]
    ds_write_b128 v56, a[32:35] offset:8192
    v_mfma_f32_16x16x32_bf16 a[60:63], v[156:159], a[76:79], a[60:63]
    v_mfma_f32_16x16x32_bf16 v[64:67], v[128:131], a[64:67], v[64:67]
    v_mfma_f32_16x16x32_bf16 v[64:67], v[192:195], a[128:131], v[64:67]
    ds_write_b128 v56, a[36:39] offset:9216
    v_mfma_f32_16x16x32_bf16 v[68:71], v[196:199], a[128:131], v[68:71]
    v_mfma_f32_16x16x32_bf16 v[68:71], v[132:135], a[64:67], v[68:71]
    v_mfma_f32_16x16x32_bf16 v[72:75], v[136:139], a[64:67], v[72:75]
    v_mfma_f32_16x16x32_bf16 v[72:75], v[200:203], a[128:131], v[72:75]
    ds_write_b128 v56, a[40:43] offset:10240
    v_mfma_f32_16x16x32_bf16 v[76:79], v[204:207], a[128:131], v[76:79]
    v_mfma_f32_16x16x32_bf16 v[76:79], v[140:143], a[64:67], v[76:79]
    v_mfma_f32_16x16x32_bf16 v[80:83], v[144:147], a[64:67], v[80:83]
    ds_write_b128 v56, a[44:47] offset:11264
    v_mfma_f32_16x16x32_bf16 v[80:83], v[208:211], a[128:131], v[80:83]
    v_mfma_f32_16x16x32_bf16 v[84:87], v[212:215], a[128:131], v[84:87]
    v_mfma_f32_16x16x32_bf16 v[84:87], v[148:151], a[64:67], v[84:87]
    ds_write_b128 v56, a[48:51] offset:12288
    v_mfma_f32_16x16x32_bf16 v[88:91], v[152:155], a[64:67], v[88:91]
    v_mfma_f32_16x16x32_bf16 v[88:91], v[216:219], a[128:131], v[88:91]
    v_mfma_f32_16x16x32_bf16 v[92:95], v[220:223], a[128:131], v[92:95]
    ds_write_b128 v56, a[52:55] offset:13312
    v_mfma_f32_16x16x32_bf16 v[92:95], v[156:159], a[64:67], v[92:95]
    v_mfma_f32_16x16x32_bf16 v[96:99], v[128:131], a[68:71], v[96:99]
    v_mfma_f32_16x16x32_bf16 v[96:99], v[192:195], a[132:135], v[96:99]
    ds_write_b128 v56, a[56:59] offset:14336
    v_mfma_f32_16x16x32_bf16 v[100:103], v[196:199], a[132:135], v[100:103]
    v_mfma_f32_16x16x32_bf16 v[100:103], v[132:135], a[68:71], v[100:103]
    v_mfma_f32_16x16x32_bf16 v[104:107], v[136:139], a[68:71], v[104:107]
    v_mfma_f32_16x16x32_bf16 v[104:107], v[200:203], a[132:135], v[104:107]
    ds_write_b128 v56, a[60:63] offset:15360
    v_mfma_f32_16x16x32_bf16 v[108:111], v[204:207], a[132:135], v[108:111]
    v_mfma_f32_16x16x32_bf16 v[108:111], v[140:143], a[68:71], v[108:111]
    v_mfma_f32_16x16x32_bf16 v[112:115], v[144:147], a[68:71], v[112:115]
    v_mfma_f32_16x16x32_bf16 v[112:115], v[208:211], a[132:135], v[112:115]
    s_waitcnt lgkmcnt(0)
    s_barrier
    ds_read_b128 v[224:227], v57
    ds_read_b128 v[228:231], v57 offset:1024
    v_mfma_f32_16x16x32_bf16 v[116:119], v[212:215], a[132:135], v[116:119]
    ds_read_b128 v[232:235], v57 offset:2048
    ds_read_b128 v[236:239], v57 offset:3072
    v_mfma_f32_16x16x32_bf16 v[116:119], v[148:151], a[68:71], v[116:119]
    ds_read_b128 v[240:243], v57 offset:4096
    ds_read_b128 v[244:247], v57 offset:5120
    v_mfma_f32_16x16x32_bf16 v[120:123], v[152:155], a[68:71], v[120:123]
    ds_read_b128 v[248:251], v57 offset:6144
    ds_read_b128 v[252:255], v57 offset:7168
    v_mfma_f32_16x16x32_bf16 v[120:123], v[216:219], a[132:135], v[120:123]
    ds_read_b128 v[160:163], v57 offset:8192
    ds_read_b128 v[164:167], v57 offset:9216
    v_mfma_f32_16x16x32_bf16 v[124:127], v[220:223], a[132:135], v[124:127]
    ds_read_b128 v[168:171], v57 offset:10240
    ds_read_b128 v[172:175], v57 offset:11264
    v_mfma_f32_16x16x32_bf16 v[124:127], v[156:159], a[68:71], v[124:127]
    ds_read_b128 v[176:179], v57 offset:12288
    ds_read_b128 v[180:183], v57 offset:13312
    ds_read_b128 v[184:187], v57 offset:14336
    ds_read_b128 v[188:191], v57 offset:15360
    s_waitcnt lgkmcnt(15)
    v_pk_add_f32 v[64:65], v[64:65], v[224:225]
    s_waitcnt lgkmcnt(14)
    s_nop 0
    v_pk_add_f32 v[68:69], v[68:69], v[228:229]
    s_waitcnt lgkmcnt(13)
    s_nop 0
    v_pk_add_f32 v[72:73], v[72:73], v[232:233]
    s_waitcnt lgkmcnt(12)
    s_nop 0
    v_pk_add_f32 v[76:77], v[76:77], v[236:237]
    v_pk_mul_f32 v[128:129], v[64:65], v[64:65]
    v_pk_mul_f32 v[130:131], v[68:69], v[68:69]
    v_pk_mul_f32 v[132:133], v[72:73], v[72:73]
    v_pk_mul_f32 v[134:135], v[76:77], v[76:77]
    v_pk_fma_f32 v[128:129], v[128:129], s[82:83], v[60:61]
    v_pk_fma_f32 v[130:131], v[130:131], s[82:83], v[60:61]
    v_pk_fma_f32 v[132:133], v[132:133], s[82:83], v[60:61]
    v_pk_fma_f32 v[134:135], v[134:135], s[82:83], v[60:61]
    v_pk_mul_f32 v[128:129], v[64:65], v[128:129]
    v_pk_mul_f32 v[130:131], v[68:69], v[130:131]
    v_pk_mul_f32 v[132:133], v[72:73], v[132:133]
    v_pk_mul_f32 v[134:135], v[76:77], v[134:135]
    v_exp_f32 v128, v128
    v_exp_f32 v129, v129
    v_exp_f32 v130, v130
    v_exp_f32 v131, v131
    v_exp_f32 v132, v132
    v_exp_f32 v133, v133
    v_exp_f32 v134, v134
    v_exp_f32 v135, v135
    v_pk_add_f32 v[128:129], v[128:129], 1.0 op_sel_hi:[1,0]
    v_pk_add_f32 v[130:131], v[130:131], 1.0 op_sel_hi:[1,0]
    v_pk_add_f32 v[132:133], v[132:133], 1.0 op_sel_hi:[1,0]
    v_pk_add_f32 v[134:135], v[134:135], 1.0 op_sel_hi:[1,0]
    v_rcp_f32 v128, v128
    v_rcp_f32 v129, v129
    v_rcp_f32 v130, v130
    v_rcp_f32 v131, v131
    v_rcp_f32 v132, v132
    v_rcp_f32 v133, v133
    v_rcp_f32 v134, v134
    v_rcp_f32 v135, v135
    v_pk_mul_f32 v[64:65], v[64:65], v[128:129]
    v_pk_mul_f32 v[68:69], v[68:69], v[130:131]
    v_pk_mul_f32 v[72:73], v[72:73], v[132:133]
    v_pk_mul_f32 v[76:77], v[76:77], v[134:135]
    v_cvt_pk_bf16_f32 v136, v64, v68
    v_cvt_pk_bf16_f32 v137, v72, v76
    v_cvt_pk_bf16_f32 v138, v65, v69
    v_cvt_pk_bf16_f32 v139, v73, v77
    v_pk_add_f32 v[66:67], v[66:67], v[226:227]
    v_pk_add_f32 v[70:71], v[70:71], v[230:231]
    v_pk_add_f32 v[74:75], v[74:75], v[234:235]
    v_pk_add_f32 v[78:79], v[78:79], v[238:239]
    v_pk_mul_f32 v[128:129], v[66:67], v[66:67]
    v_pk_mul_f32 v[130:131], v[70:71], v[70:71]
    v_pk_mul_f32 v[132:133], v[74:75], v[74:75]
    v_pk_mul_f32 v[134:135], v[78:79], v[78:79]
    v_pk_fma_f32 v[128:129], v[128:129], s[82:83], v[60:61]
    v_pk_fma_f32 v[130:131], v[130:131], s[82:83], v[60:61]
    v_pk_fma_f32 v[132:133], v[132:133], s[82:83], v[60:61]
    v_pk_fma_f32 v[134:135], v[134:135], s[82:83], v[60:61]
    v_pk_mul_f32 v[128:129], v[66:67], v[128:129]
    v_pk_mul_f32 v[130:131], v[70:71], v[130:131]
    v_pk_mul_f32 v[132:133], v[74:75], v[132:133]
    v_pk_mul_f32 v[134:135], v[78:79], v[134:135]
    v_exp_f32 v128, v128
    v_exp_f32 v129, v129
    v_mfma_f32_16x16x32_bf16 v[144:147], a[160:163], v[136:139], 0
    v_exp_f32 v130, v130
    v_exp_f32 v131, v131
    v_exp_f32 v132, v132
    v_exp_f32 v133, v133
    v_exp_f32 v134, v134
    v_exp_f32 v135, v135
    v_pk_add_f32 v[128:129], v[128:129], 1.0 op_sel_hi:[1,0]
    v_pk_add_f32 v[130:131], v[130:131], 1.0 op_sel_hi:[1,0]
    v_pk_add_f32 v[132:133], v[132:133], 1.0 op_sel_hi:[1,0]
    v_pk_add_f32 v[134:135], v[134:135], 1.0 op_sel_hi:[1,0]
    v_rcp_f32 v128, v128
    v_rcp_f32 v129, v129
    v_rcp_f32 v130, v130
    v_rcp_f32 v131, v131
    v_rcp_f32 v132, v132
    v_rcp_f32 v133, v133
    v_rcp_f32 v134, v134
    v_rcp_f32 v135, v135
    v_pk_mul_f32 v[66:67], v[66:67], v[128:129]
    v_pk_mul_f32 v[70:71], v[70:71], v[130:131]
    v_pk_mul_f32 v[74:75], v[74:75], v[132:133]
    v_pk_mul_f32 v[78:79], v[78:79], v[134:135]
    v_cvt_pk_bf16_f32 v140, v66, v70
    v_cvt_pk_bf16_f32 v141, v74, v78
    v_cvt_pk_bf16_f32 v142, v67, v71
    v_cvt_pk_bf16_f32 v143, v75, v79
    s_waitcnt lgkmcnt(0)
    s_nop 0
    v_pk_add_f32 v[80:81], v[80:81], v[240:241]
    v_pk_add_f32 v[84:85], v[84:85], v[244:245]
    v_pk_add_f32 v[88:89], v[88:89], v[248:249]
    v_pk_add_f32 v[92:93], v[92:93], v[252:253]
    v_pk_mul_f32 v[128:129], v[80:81], v[80:81]
    v_pk_mul_f32 v[130:131], v[84:85], v[84:85]
    v_pk_mul_f32 v[132:133], v[88:89], v[88:89]
    v_pk_mul_f32 v[134:135], v[92:93], v[92:93]
    v_pk_fma_f32 v[128:129], v[128:129], s[82:83], v[60:61]
    v_pk_fma_f32 v[130:131], v[130:131], s[82:83], v[60:61]
    v_pk_fma_f32 v[132:133], v[132:133], s[82:83], v[60:61]
    v_pk_fma_f32 v[134:135], v[134:135], s[82:83], v[60:61]
    v_pk_mul_f32 v[128:129], v[80:81], v[128:129]
    v_pk_mul_f32 v[130:131], v[84:85], v[130:131]
    v_pk_mul_f32 v[132:133], v[88:89], v[132:133]
    v_pk_mul_f32 v[134:135], v[92:93], v[134:135]
    v_exp_f32 v128, v128
    v_exp_f32 v129, v129
    v_mfma_f32_16x16x32_bf16 v[144:147], a[164:167], v[140:143], v[144:147]
    v_exp_f32 v130, v130
    v_exp_f32 v131, v131
    v_exp_f32 v132, v132
    v_exp_f32 v133, v133
    v_exp_f32 v134, v134
    v_exp_f32 v135, v135
    v_pk_add_f32 v[128:129], v[128:129], 1.0 op_sel_hi:[1,0]
    v_pk_add_f32 v[130:131], v[130:131], 1.0 op_sel_hi:[1,0]
    v_pk_add_f32 v[132:133], v[132:133], 1.0 op_sel_hi:[1,0]
    v_pk_add_f32 v[134:135], v[134:135], 1.0 op_sel_hi:[1,0]
    v_rcp_f32 v128, v128
    v_rcp_f32 v129, v129
    v_rcp_f32 v130, v130
    v_rcp_f32 v131, v131
    v_rcp_f32 v132, v132
    v_rcp_f32 v133, v133
    v_rcp_f32 v134, v134
    v_rcp_f32 v135, v135
    v_pk_mul_f32 v[80:81], v[80:81], v[128:129]
    v_pk_mul_f32 v[84:85], v[84:85], v[130:131]
    v_pk_mul_f32 v[88:89], v[88:89], v[132:133]
    v_pk_mul_f32 v[92:93], v[92:93], v[134:135]
    v_cvt_pk_bf16_f32 v136, v80, v84
    v_cvt_pk_bf16_f32 v137, v88, v92
    v_cvt_pk_bf16_f32 v138, v81, v85
    v_cvt_pk_bf16_f32 v139, v89, v93
    v_pk_add_f32 v[82:83], v[82:83], v[242:243]
    v_pk_add_f32 v[86:87], v[86:87], v[246:247]
    v_pk_add_f32 v[90:91], v[90:91], v[250:251]
    v_pk_add_f32 v[94:95], v[94:95], v[254:255]
    v_pk_mul_f32 v[128:129], v[82:83], v[82:83]
    v_pk_mul_f32 v[130:131], v[86:87], v[86:87]
    v_pk_mul_f32 v[132:133], v[90:91], v[90:91]
    v_pk_mul_f32 v[134:135], v[94:95], v[94:95]
    v_pk_fma_f32 v[128:129], v[128:129], s[82:83], v[60:61]
    v_pk_fma_f32 v[130:131], v[130:131], s[82:83], v[60:61]
    v_pk_fma_f32 v[132:133], v[132:133], s[82:83], v[60:61]
    v_pk_fma_f32 v[134:135], v[134:135], s[82:83], v[60:61]
    v_pk_mul_f32 v[128:129], v[82:83], v[128:129]
    v_pk_mul_f32 v[130:131], v[86:87], v[130:131]
    v_pk_mul_f32 v[132:133], v[90:91], v[132:133]
    v_pk_mul_f32 v[134:135], v[94:95], v[134:135]
    v_exp_f32 v128, v128
    v_exp_f32 v129, v129
    v_mfma_f32_16x16x32_bf16 v[144:147], a[168:171], v[136:139], v[144:147]
    v_exp_f32 v130, v130
    v_exp_f32 v131, v131
    v_exp_f32 v132, v132
    v_exp_f32 v133, v133
    v_exp_f32 v134, v134
    v_exp_f32 v135, v135
    v_pk_add_f32 v[128:129], v[128:129], 1.0 op_sel_hi:[1,0]
    v_pk_add_f32 v[130:131], v[130:131], 1.0 op_sel_hi:[1,0]
    v_pk_add_f32 v[132:133], v[132:133], 1.0 op_sel_hi:[1,0]
    v_pk_add_f32 v[134:135], v[134:135], 1.0 op_sel_hi:[1,0]
    v_rcp_f32 v128, v128
    v_rcp_f32 v129, v129
    v_rcp_f32 v130, v130
    v_rcp_f32 v131, v131
    v_rcp_f32 v132, v132
    v_rcp_f32 v133, v133
    v_rcp_f32 v134, v134
    v_rcp_f32 v135, v135
    v_pk_mul_f32 v[82:83], v[82:83], v[128:129]
    v_pk_mul_f32 v[86:87], v[86:87], v[130:131]
    v_pk_mul_f32 v[90:91], v[90:91], v[132:133]
    v_pk_mul_f32 v[94:95], v[94:95], v[134:135]
    v_cvt_pk_bf16_f32 v140, v82, v86
    v_cvt_pk_bf16_f32 v141, v90, v94
    v_cvt_pk_bf16_f32 v142, v83, v87
    v_cvt_pk_bf16_f32 v143, v91, v95
    v_pk_add_f32 v[96:97], v[96:97], v[160:161]
    v_pk_add_f32 v[100:101], v[100:101], v[164:165]
    v_mfma_f32_16x16x32_bf16 v[144:147], a[172:175], v[140:143], v[144:147]
    v_pk_add_f32 v[104:105], v[104:105], v[168:169]
    v_pk_add_f32 v[108:109], v[108:109], v[172:173]
    v_pk_mul_f32 v[128:129], v[96:97], v[96:97]
    v_pk_mul_f32 v[130:131], v[100:101], v[100:101]
    v_pk_mul_f32 v[132:133], v[104:105], v[104:105]
    v_pk_mul_f32 v[134:135], v[108:109], v[108:109]
    v_pk_fma_f32 v[128:129], v[128:129], s[82:83], v[60:61]
    v_pk_fma_f32 v[130:131], v[130:131], s[82:83], v[60:61]
    v_pk_fma_f32 v[132:133], v[132:133], s[82:83], v[60:61]
    v_pk_fma_f32 v[134:135], v[134:135], s[82:83], v[60:61]
    v_mov_b32 v8, v144
    buffer_store_dwordx2 v[8:9], v54, s[44:47], 0 offen sc1
    s_cmp_eq_u32 s61, 0xffff
    s_cbranch_scc0 L_slowsend
L_sent:
    v_pk_mul_f32 v[128:129], v[96:97], v[128:129]
    v_pk_mul_f32 v[130:131], v[100:101], v[130:131]
    v_pk_mul_f32 v[132:133], v[104:105], v[132:133]
    v_pk_mul_f32 v[134:135], v[108:109], v[134:135]
    v_exp_f32 v128, v128
    v_exp_f32 v129, v129
    v_exp_f32 v130, v130
    v_exp_f32 v131, v131
    v_exp_f32 v132, v132
    v_exp_f32 v133, v133
    v_exp_f32 v134, v134
    v_exp_f32 v135, v135
    v_pk_add_f32 v[128:129], v[128:129], 1.0 op_sel_hi:[1,0]
    v_pk_add_f32 v[130:131], v[130:131], 1.0 op_sel_hi:[1,0]
    v_pk_add_f32 v[132:133], v[132:133], 1.0 op_sel_hi:[1,0]
    v_pk_add_f32 v[134:135], v[134:135], 1.0 op_sel_hi:[1,0]
    v_rcp_f32 v128, v128
    v_rcp_f32 v129, v129
    v_rcp_f32 v130, v130
    v_rcp_f32 v131, v131
    v_rcp_f32 v132, v132
    v_rcp_f32 v133, v133
    v_rcp_f32 v134, v134
    v_rcp_f32 v135, v135
    v_pk_mul_f32 v[96:97], v[96:97], v[128:129]
    v_pk_mul_f32 v[100:101], v[100:101], v[130:131]
    v_pk_mul_f32 v[104:105], v[104:105], v[132:133]
    v_pk_mul_f32 v[108:109], v[108:109], v[134:135]
    v_cvt_pk_bf16_f32 v136, v96, v100
    v_cvt_pk_bf16_f32 v137, v104, v108
    v_cvt_pk_bf16_f32 v138, v97, v101
    v_cvt_pk_bf16_f32 v139, v105, v109
    v_pk_add_f32 v[98:99], v[98:99], v[162:163]
    v_pk_add_f32 v[102:103], v[102:103], v[166:167]
    v_pk_add_f32 v[106:107], v[106:107], v[170:171]
    v_pk_add_f32 v[110:111], v[110:111], v[174:175]
    v_pk_mul_f32 v[128:129], v[98:99], v[98:99]
    v_pk_mul_f32 v[130:131], v[102:103], v[102:103]
    v_pk_mul_f32 v[132:133], v[106:107], v[106:107]
    v_pk_mul_f32 v[134:135], v[110:111], v[110:111]
    v_pk_fma_f32 v[128:129], v[128:129], s[82:83], v[60:61]
    v_pk_fma_f32 v[130:131], v[130:131], s[82:83], v[60:61]
    v_pk_fma_f32 v[132:133], v[132:133], s[82:83], v[60:61]
    v_pk_fma_f32 v[134:135], v[134:135], s[82:83], v[60:61]
    v_pk_mul_f32 v[128:129], v[98:99], v[128:129]
    v_pk_mul_f32 v[130:131], v[102:103], v[130:131]
    v_pk_mul_f32 v[132:133], v[106:107], v[132:133]
    v_pk_mul_f32 v[134:135], v[110:111], v[134:135]
    v_exp_f32 v128, v128
    v_exp_f32 v129, v129
    v_mfma_f32_16x16x32_bf16 v[148:151], a[160:163], v[136:139], 0
    v_exp_f32 v130, v130
    v_exp_f32 v131, v131
    v_exp_f32 v132, v132
    v_exp_f32 v133, v133
    v_exp_f32 v134, v134
    v_exp_f32 v135, v135
    v_pk_add_f32 v[128:129], v[128:129], 1.0 op_sel_hi:[1,0]
    v_pk_add_f32 v[130:131], v[130:131], 1.0 op_sel_hi:[1,0]
    v_pk_add_f32 v[132:133], v[132:133], 1.0 op_sel_hi:[1,0]
    v_pk_add_f32 v[134:135], v[134:135], 1.0 op_sel_hi:[1,0]
    v_rcp_f32 v128, v128
    v_rcp_f32 v129, v129
    v_rcp_f32 v130, v130
    v_rcp_f32 v131, v131
    v_rcp_f32 v132, v132
    v_rcp_f32 v133, v133
    v_rcp_f32 v134, v134
    v_rcp_f32 v135, v135
    v_pk_mul_f32 v[98:99], v[98:99], v[128:129]
    v_pk_mul_f32 v[102:103], v[102:103], v[130:131]
    v_pk_mul_f32 v[106:107], v[106:107], v[132:133]
    v_pk_mul_f32 v[110:111], v[110:111], v[134:135]
    v_cvt_pk_bf16_f32 v140, v98, v102
    v_cvt_pk_bf16_f32 v141, v106, v110
    v_cvt_pk_bf16_f32 v142, v99, v103
    v_cvt_pk_bf16_f32 v143, v107, v111
    v_pk_add_f32 v[112:113], v[112:113], v[176:177]
    v_pk_add_f32 v[116:117], v[116:117], v[180:181]
    v_pk_add_f32 v[120:121], v[120:121], v[184:185]
    v_pk_add_f32 v[124:125], v[124:125], v[188:189]
    v_pk_mul_f32 v[128:129], v[112:113], v[112:113]
    v_pk_mul_f32 v[130:131], v[116:117], v[116:117]
    v_pk_mul_f32 v[132:133], v[120:121], v[120:121]
    v_pk_mul_f32 v[134:135], v[124:125], v[124:125]
    v_pk_fma_f32 v[128:129], v[128:129], s[82:83], v[60:61]
    v_pk_fma_f32 v[130:131], v[130:131], s[82:83], v[60:61]
    v_pk_fma_f32 v[132:133], v[132:133], s[82:83], v[60:61]
    v_pk_fma_f32 v[134:135], v[134:135], s[82:83], v[60:61]
    buffer_load_dwordx2 v[10:11], v52, s[44:47], 0 offen sc1
    v_pk_mul_f32 v[128:129], v[112:113], v[128:129]
    v_pk_mul_f32 v[130:131], v[116:117], v[130:131]
    v_pk_mul_f32 v[132:133], v[120:121], v[132:133]
    v_pk_mul_f32 v[134:135], v[124:125], v[134:135]
    v_exp_f32 v128, v128
    v_exp_f32 v129, v129
    v_mfma_f32_16x16x32_bf16 v[148:151], a[164:167], v[140:143], v[148:151]
    v_exp_f32 v130, v130
    v_exp_f32 v131, v131
    v_exp_f32 v132, v132
    v_exp_f32 v133, v133
    v_exp_f32 v134, v134
    v_exp_f32 v135, v135
    v_pk_add_f32 v[128:129], v[128:129], 1.0 op_sel_hi:[1,0]
    v_pk_add_f32 v[130:131], v[130:131], 1.0 op_sel_hi:[1,0]
    v_pk_add_f32 v[132:133], v[132:133], 1.0 op_sel_hi:[1,0]
    v_pk_add_f32 v[134:135], v[134:135], 1.0 op_sel_hi:[1,0]
    v_rcp_f32 v128, v128
    v_rcp_f32 v129, v129
    v_rcp_f32 v130, v130
    v_rcp_f32 v131, v131
    v_rcp_f32 v132, v132
    v_rcp_f32 v133, v133
    v_rcp_f32 v134, v134
    v_rcp_f32 v135, v135
    v_pk_mul_f32 v[112:113], v[112:113], v[128:129]
    v_pk_mul_f32 v[116:117], v[116:117], v[130:131]
    v_pk_mul_f32 v[120:121], v[120:121], v[132:133]
    v_pk_mul_f32 v[124:125], v[124:125], v[134:135]
    v_cvt_pk_bf16_f32 v136, v112, v116
    v_cvt_pk_bf16_f32 v137, v120, v124
    v_cvt_pk_bf16_f32 v138, v113, v117
    v_cvt_pk_bf16_f32 v139, v121, v125
    v_pk_add_f32 v[114:115], v[114:115], v[178:179]
    v_pk_add_f32 v[118:119], v[118:119], v[182:183]
    v_pk_add_f32 v[122:123], v[122:123], v[186:187]
    v_pk_add_f32 v[126:127], v[126:127], v[190:191]
    v_pk_mul_f32 v[128:129], v[114:115], v[114:115]
    v_pk_mul_f32 v[130:131], v[118:119], v[118:119]
    v_pk_mul_f32 v[132:133], v[122:123], v[122:123]
    v_pk_mul_f32 v[134:135], v[126:127], v[126:127]
    v_pk_fma_f32 v[128:129], v[128:129], s[82:83], v[60:61]
    v_pk_fma_f32 v[130:131], v[130:131], s[82:83], v[60:61]
    v_pk_fma_f32 v[132:133], v[132:133], s[82:83], v[60:61]
    v_pk_fma_f32 v[134:135], v[134:135], s[82:83], v[60:61]
    v_pk_mul_f32 v[128:129], v[114:115], v[128:129]
    v_pk_mul_f32 v[130:131], v[118:119], v[130:131]
    v_pk_mul_f32 v[132:133], v[122:123], v[132:133]
    v_pk_mul_f32 v[134:135], v[126:127], v[134:135]
    v_exp_f32 v128, v128
    v_exp_f32 v129, v129
    v_mfma_f32_16x16x32_bf16 v[148:151], a[168:171], v[136:139], v[148:151]
    v_exp_f32 v130, v130
    v_exp_f32 v131, v131
    v_exp_f32 v132, v132
    v_exp_f32 v133, v133
    v_exp_f32 v134, v134
    v_exp_f32 v135, v135
    v_pk_add_f32 v[128:129], v[128:129], 1.0 op_sel_hi:[1,0]
    v_pk_add_f32 v[130:131], v[130:131], 1.0 op_sel_hi:[1,0]
    v_pk_add_f32 v[132:133], v[132:133], 1.0 op_sel_hi:[1,0]
    v_pk_add_f32 v[134:135], v[134:135], 1.0 op_sel_hi:[1,0]
    v_rcp_f32 v128, v128
    v_rcp_f32 v129, v129
    v_rcp_f32 v130, v130
    v_rcp_f32 v131, v131
    v_rcp_f32 v132, v132
    v_rcp_f32 v133, v133
    v_rcp_f32 v134, v134
    v_rcp_f32 v135, v135
    v_pk_mul_f32 v[114:115], v[114:115], v[128:129]
    v_pk_mul_f32 v[118:119], v[118:119], v[130:131]
    v_pk_mul_f32 v[122:123], v[122:123], v[132:133]
    v_pk_mul_f32 v[126:127], v[126:127], v[134:135]
    v_cvt_pk_bf16_f32 v140, v114, v118
    v_cvt_pk_bf16_f32 v141, v122, v126
    v_cvt_pk_bf16_f32 v142, v115, v119
    v_cvt_pk_bf16_f32 v143, v123, v127
    s_nop 1
    v_mfma_f32_16x16x32_bf16 v[148:151], a[172:175], v[140:143], v[148:151]
L_chk:
    s_waitcnt vmcnt(0)
    v_cmp_ne_u32 vcc, v11, v53
    s_lshr_b32 s61, vcc_lo, 16
    s_cmp_eq_u32 s61, 0xffff
    s_cbranch_scc0 L_retry
L_got:
    v_add_f32 v55, v55, v10
    s_nop 1
    v_add_f32 v55, v55, v148
    v_cvt_pk_bf16_f32 v55, v55, v55
    buffer_store_short v55, v12, s[36:39], s43 offen
L_fin:
    s_endpgm
L_slowsend:
    s_mov_b64 s[92:93], s[84:85]
    s_mov_b32 s94, 256
    s_mov_b32 s95, 0x20000
    s_lshl_b32 s64, s2, 2
    s_add_u32 s64, s64, s76
    s_and_b32 s63, s64, 31
    s_lshl_b32 s63, 1, s63
    s_lshr_b32 s64, s64, 5
    s_lshl_b32 s64, s64, 2
    v_and_b32 v13, 63, v0
    v_lshlrev_b32 v13, 16, v13
    v_mov_b32 v14, s63
    s_waitcnt vmcnt(0)
    buffer_atomic_or v14, v13, s[92:95], s64 offen sc1
    s_waitcnt vmcnt(0)
    s_branch L_sent
L_retry:
    s_add_u32 s62, s62, 1
    s_and_b32 s63, s62, 7
    s_cbranch_scc0 L_retry_bit
    buffer_load_dwordx2 v[10:11], v52, s[44:47], 0 offen sc1
    s_waitcnt vmcnt(0)
    s_branch L_chk
L_retry_bit:
    s_cmp_gt_u32 s62, 0x400000
    s_cbranch_scc1 L_got
    s_mov_b64 s[92:93], s[84:85]
    s_mov_b32 s94, 256
    s_mov_b32 s95, 0x20000
    s_xor_b32 s63, s2, 1
    s_lshl_b32 s63, s63, 2
    s_add_u32 s63, s63, s76
    s_lshr_b32 s64, s63, 5
    s_lshl_b32 s64, s64, 2
    s_and_b32 s63, s63, 31
    v_mov_b32 v13, 0
    buffer_load_dword v14, v13, s[92:95], s64 offen sc1
    s_waitcnt vmcnt(0)
    buffer_load_dwordx2 v[10:11], v52, s[44:47], 0 offen sc1
    v_readfirstlane_b32 s64, v14
    s_waitcnt vmcnt(0)
    s_bitcmp1_b32 s64, s63
    s_cbranch_scc1 L_got
    s_branch L_chk
L_end:
    s_endpgm
.section .rodata,"a"
.p2align 6
.amdhsa_kernel standalone__deep_cross_pnn__recsys_kernel
  .amdhsa_next_free_vgpr 512
  .amdhsa_next_free_sgpr 102
  .amdhsa_accum_offset 256
  .amdhsa_group_segment_fixed_size 0
  .amdhsa_kernarg_size 80
  .amdhsa_user_sgpr_count 2
  .amdhsa_user_sgpr_kernarg_segment_ptr 1
  .amdhsa_system_sgpr_workgroup_id_x 1
.end_amdhsa_kernel
```
